```python
import torch

def _softmax(x, axis=-1):
    return torch.softmax(x, dim=axis)
def _gelu(x):
    return torch.nn.functional.gelu(x, approximate="tanh")
def _silu(x):
    return torch.nn.functional.silu(x)
def _sigmoid(x):
    return torch.sigmoid(x)
def _layernorm(x, axis=-1, eps=1e-5):
    m = x.mean(dim=axis, keepdim=True)
    v = x.var(dim=axis, keepdim=True, unbiased=False)
    return (x - m) / torch.sqrt(v + eps)
def _scatter_add(tgt, idx, src, axis=0):
    return tgt.clone().index_add_(axis, idx, src)
def _segment_sum(src, seg, n):
    out = torch.zeros((n,) + src.shape[1:], dtype=src.dtype)
    return out.index_add_(0, seg, src)
def _pad(x, pw):
    flat = tuple(v for pair in reversed(pw) for v in pair)
    return torch.nn.functional.pad(x, flat)

kernel_name = 'standalone__molecular_angular_dimenet__graph'

def setup_inputs():

    _w = (lambda a: (lambda t: t.to(torch.bfloat16) if t.is_floating_point() else t)(torch.as_tensor(a)))
    N, deg, D = 10000, 16, 128
    n_rbf, L = max(0, 1), max(3, 1)
    E = N * deg
    T = E * deg
    d = torch.abs((lambda *s: torch.randn(*s, dtype=torch.bfloat16) * 0.05)(E)) + 0.5
    theta = torch.abs((lambda *s: torch.randn(*s, dtype=torch.bfloat16) * 0.05)(T)) * 0.8 + 0.1
    return {
        "h": _w((lambda *s: torch.randn(*s, dtype=torch.bfloat16) * 0.05)(E, D)),
        "d": _w(d),
        "theta": _w(theta),
        "idx_kj": _w((lambda lo, hi, *s: torch.randint(lo, hi, s))(0, E, T).to(torch.int64)),
        "idx_ji": _w((lambda lo, hi, *s: torch.randint(lo, hi, s))(0, E, T).to(torch.int64)),
        "freq": _w(torch.arange(1, n_rbf + 1).to(float) * torch.pi / 5.0),
        "ell": _w(torch.arange(1, L + 1).to(float)),
        "w_sbf": _w((lambda *s: torch.randn(*s, dtype=torch.bfloat16) * 0.05)(n_rbf * L, D) * (n_rbf * L) ** -0.5),
        "w_rbf": _w((lambda *s: torch.randn(*s, dtype=torch.bfloat16) * 0.1)(n_rbf, D) * n_rbf ** -0.5),
    }

def reference(h, d, theta, idx_kj, idx_ji, freq, ell, w_sbf, w_rbf):
    E = h.shape[0]
    n_rbf = freq.shape[0]
    L = ell.shape[0]
    rbf = torch.sin(d[:, None] * freq[None, :]) / d[:, None]
    d_kj = d[idx_kj]
    rad = torch.sin(d_kj[:, None] * freq[None, :]) / d_kj[:, None]
    ang = torch.cos(theta[:, None] * ell[None, :])
    sbf = torch.reshape(rad[:, :, None] * ang[:, None, :], (-1, n_rbf * L))
    m = h[idx_kj] * (sbf @ w_sbf)
    agg = _segment_sum(m, idx_ji, E)
    return h * (rbf @ w_rbf) + agg
```

```asm
; @launch kernel=bucket_kernel grid=(250,1,1) block=(1024,1,1) lds=162816
; @launch kernel=sweep_kernel grid=(256,1,1) block=(512,1,1) lds=162816
.amdgcn_target "amdgcn-amd-amdhsa--gfx950"
.text
.p2align 8
.globl bucket_kernel
.type bucket_kernel,@function
bucket_kernel:
    s_load_dwordx2 s[20:21], s[0:1], 24
    s_load_dwordx2 s[36:37], s[0:1], 8
    s_load_dwordx2 s[16:17], s[0:1], 32
    s_load_dwordx2 s[24:25], s[0:1], 16
    s_load_dwordx2 s[28:29], s[0:1], 88
    s_cmp_ge_u32 s2, 250
    s_cbranch_scc1 K1_end
    v_readfirstlane_b32 s15, v0
    v_lshlrev_b32 v1, 4, v0
    v_lshlrev_b32 v2, 3, v0
    s_mul_i32 s48, s2, 40960
    s_lshr_b32 s15, s15, 6
    v_and_b32 v89, 0x3f0, v1
    s_add_u32 s49, s48, 16384
    s_add_u32 s50, s48, 32768
    s_mov_b32 s22, 10240000
    s_mov_b32 s23, 0x20000
    s_mov_b32 s38, 320000
    s_mov_b32 s39, 0x20000
    s_waitcnt lgkmcnt(0)
    s_bitcmp1_b32 s2, 3
    s_cbranch_scc1 K1_later
    buffer_load_dwordx4 v[16:19], v1, s[20:23], s48 offen nt
    buffer_load_dwordx4 v[20:23], v1, s[20:23], s49 offen nt
    buffer_load_dwordx2 v[24:25], v2, s[20:23], s50 offen nt
K1_later:
    s_lshr_b32 s35, s2, 3
    s_mul_i32 s35, s35, 5
    s_add_u32 s35, s35, s15
    s_lshl_b32 s35, s35, 10
    s_cmp_ge_u32 s35, 163840
    s_cselect_b32 s34, 163840, 0
    s_sub_u32 s35, s35, s34
    s_min_u32 s34, s35, 159744
    s_add_u32 m0, s34, 2048
    s_add_u32 s34, s34, 0
    buffer_load_dwordx4 v89, s[36:39], s34 offen lds
    s_add_u32 s35, s35, 16384
    s_cmp_ge_u32 s35, 163840
    s_cselect_b32 s34, 163840, 0
    s_sub_u32 s35, s35, s34
    s_min_u32 s34, s35, 159744
    s_add_u32 m0, s34, 2048
    s_add_u32 s34, s34, 0
    buffer_load_dwordx4 v89, s[36:39], s34 offen lds
    s_add_u32 s35, s35, 16384
    s_cmp_ge_u32 s35, 163840
    s_cselect_b32 s34, 163840, 0
    s_sub_u32 s35, s35, s34
    s_min_u32 s34, s35, 159744
    s_add_u32 m0, s34, 2048
    s_add_u32 s34, s34, 0
    buffer_load_dwordx4 v89, s[36:39], s34 offen lds
    s_add_u32 s35, s35, 16384
    s_cmp_ge_u32 s35, 163840
    s_cselect_b32 s34, 163840, 0
    s_sub_u32 s35, s35, s34
    s_min_u32 s34, s35, 159744
    s_add_u32 m0, s34, 2048
    s_add_u32 s34, s34, 0
    buffer_load_dwordx4 v89, s[36:39], s34 offen lds
    s_add_u32 s35, s35, 16384
    s_cmp_ge_u32 s35, 163840
    s_cselect_b32 s34, 163840, 0
    s_sub_u32 s35, s35, s34
    s_min_u32 s34, s35, 159744
    s_add_u32 m0, s34, 2048
    s_add_u32 s34, s34, 0
    buffer_load_dwordx4 v89, s[36:39], s34 offen lds
    s_add_u32 s35, s35, 16384
    s_cmp_ge_u32 s35, 163840
    s_cselect_b32 s34, 163840, 0
    s_sub_u32 s35, s35, s34
    s_min_u32 s34, s35, 159744
    s_add_u32 m0, s34, 2048
    s_add_u32 s34, s34, 0
    buffer_load_dwordx4 v89, s[36:39], s34 offen lds
    s_add_u32 s35, s35, 16384
    s_cmp_ge_u32 s35, 163840
    s_cselect_b32 s34, 163840, 0
    s_sub_u32 s35, s35, s34
    s_min_u32 s34, s35, 159744
    s_add_u32 m0, s34, 2048
    s_add_u32 s34, s34, 0
    buffer_load_dwordx4 v89, s[36:39], s34 offen lds
    s_add_u32 s35, s35, 16384
    s_cmp_ge_u32 s35, 163840
    s_cselect_b32 s34, 163840, 0
    s_sub_u32 s35, s35, s34
    s_min_u32 s34, s35, 159744
    s_add_u32 m0, s34, 2048
    s_add_u32 s34, s34, 0
    buffer_load_dwordx4 v89, s[36:39], s34 offen lds
    s_add_u32 s35, s35, 16384
    s_cmp_ge_u32 s35, 163840
    s_cselect_b32 s34, 163840, 0
    s_sub_u32 s35, s35, s34
    s_min_u32 s34, s35, 159744
    s_add_u32 m0, s34, 2048
    s_add_u32 s34, s34, 0
    buffer_load_dwordx4 v89, s[36:39], s34 offen lds
    s_add_u32 s35, s35, 16384
    s_cmp_ge_u32 s35, 163840
    s_cselect_b32 s34, 163840, 0
    s_sub_u32 s35, s35, s34
    s_min_u32 s34, s35, 159744
    s_add_u32 m0, s34, 2048
    s_add_u32 s34, s34, 0
    buffer_load_dwordx4 v89, s[36:39], s34 offen lds
    v_lshlrev_b32 v3, 2, v0
    s_mul_i32 s56, s2, 20480
    s_add_u32 s57, s56, 8192
    s_add_u32 s58, s56, 16384
    s_mov_b32 s18, 10240000
    s_mov_b32 s19, 0x20000
    s_mov_b32 s26, 5120000
    s_mov_b32 s27, 0x20000
    s_mov_b32 s30, 21751808
    s_mov_b32 s31, 0x20000
    v_mov_b32 v90, 0
    v_and_b32 v91, 0x3fc, v3
    v_mov_b32 v88, 1
    s_mov_b32 s46, 0xfe
    s_mov_b32 s47, 160000
    ds_write_b32 v91, v90 offset:0
    s_bitcmp0_b32 s2, 3
    s_cbranch_scc1 K1_both
    s_barrier
    buffer_load_dwordx4 v[16:19], v1, s[20:23], s48 offen nt
    buffer_load_dwordx4 v[20:23], v1, s[20:23], s49 offen nt
    buffer_load_dwordx2 v[24:25], v2, s[20:23], s50 offen nt
K1_both:
    s_barrier
    buffer_load_dwordx4 v[4:7], v1, s[16:19], s48 offen nt
    buffer_load_dwordx4 v[8:11], v1, s[16:19], s49 offen nt
    buffer_load_dwordx2 v[12:13], v2, s[16:19], s50 offen nt
    buffer_load_dwordx2 v[28:29], v2, s[24:27], s56 offen nt
    buffer_load_dwordx2 v[30:31], v2, s[24:27], s57 offen nt
    buffer_load_dword v32, v3, s[24:27], s58 offen nt
    s_waitcnt vmcnt(6)
    v_lshlrev_b32 v34, 8, v16
    v_lshlrev_b32 v16, 1, v16
    v_lshlrev_b32 v36, 8, v17
    v_lshlrev_b32 v17, 1, v17
    v_lshlrev_b32 v38, 8, v18
    v_lshlrev_b32 v18, 1, v18
    v_lshlrev_b32 v40, 8, v19
    v_lshlrev_b32 v19, 1, v19
    v_lshlrev_b32 v42, 8, v20
    v_lshlrev_b32 v20, 1, v20
    v_lshlrev_b32 v44, 8, v21
    v_lshlrev_b32 v21, 1, v21
    v_lshlrev_b32 v46, 8, v22
    v_lshlrev_b32 v22, 1, v22
    v_lshlrev_b32 v48, 8, v23
    v_lshlrev_b32 v23, 1, v23
    v_lshlrev_b32 v50, 8, v24
    v_lshlrev_b32 v24, 1, v24
    v_lshlrev_b32 v52, 8, v25
    v_lshlrev_b32 v25, 1, v25
    s_barrier
    v_cmpx_gt_u32 vcc, s47, v16
    ds_read_u16 v74, v16 offset:2048
    s_mov_b64 exec, -1
    v_cmpx_gt_u32 vcc, s47, v17
    ds_read_u16 v75, v17 offset:2048
    s_mov_b64 exec, -1
    v_cmpx_gt_u32 vcc, s47, v18
    ds_read_u16 v76, v18 offset:2048
    s_mov_b64 exec, -1
    v_cmpx_gt_u32 vcc, s47, v19
    ds_read_u16 v77, v19 offset:2048
    s_mov_b64 exec, -1
    v_cmpx_gt_u32 vcc, s47, v20
    ds_read_u16 v78, v20 offset:2048
    s_mov_b64 exec, -1
    v_cmpx_gt_u32 vcc, s47, v21
    ds_read_u16 v79, v21 offset:2048
    s_mov_b64 exec, -1
    v_cmpx_gt_u32 vcc, s47, v22
    ds_read_u16 v80, v22 offset:2048
    s_mov_b64 exec, -1
    v_cmpx_gt_u32 vcc, s47, v23
    ds_read_u16 v81, v23 offset:2048
    s_mov_b64 exec, -1
    v_cmpx_gt_u32 vcc, s47, v24
    ds_read_u16 v82, v24 offset:2048
    s_mov_b64 exec, -1
    v_cmpx_gt_u32 vcc, s47, v25
    ds_read_u16 v83, v25 offset:2048
    s_mov_b64 exec, -1
    s_waitcnt lgkmcnt(0)
    s_barrier
    s_waitcnt vmcnt(5)
    v_lshlrev_b32_sdwa v54, 2, v4 dst_sel:DWORD dst_unused:UNUSED_PAD src0_sel:DWORD src1_sel:BYTE_0
    v_lshlrev_b32_sdwa v55, 2, v5 dst_sel:DWORD dst_unused:UNUSED_PAD src0_sel:DWORD src1_sel:BYTE_0
    v_lshlrev_b32_sdwa v56, 2, v6 dst_sel:DWORD dst_unused:UNUSED_PAD src0_sel:DWORD src1_sel:BYTE_0
    v_lshlrev_b32_sdwa v57, 2, v7 dst_sel:DWORD dst_unused:UNUSED_PAD src0_sel:DWORD src1_sel:BYTE_0
    ds_add_rtn_u32 v64, v54, v88 offset:0
    ds_add_rtn_u32 v65, v55, v88 offset:0
    ds_add_rtn_u32 v66, v56, v88 offset:0
    ds_add_rtn_u32 v67, v57, v88 offset:0
    s_waitcnt vmcnt(4)
    v_lshlrev_b32_sdwa v58, 2, v8 dst_sel:DWORD dst_unused:UNUSED_PAD src0_sel:DWORD src1_sel:BYTE_0
    v_lshlrev_b32_sdwa v59, 2, v9 dst_sel:DWORD dst_unused:UNUSED_PAD src0_sel:DWORD src1_sel:BYTE_0
    v_lshlrev_b32_sdwa v60, 2, v10 dst_sel:DWORD dst_unused:UNUSED_PAD src0_sel:DWORD src1_sel:BYTE_0
    v_lshlrev_b32_sdwa v61, 2, v11 dst_sel:DWORD dst_unused:UNUSED_PAD src0_sel:DWORD src1_sel:BYTE_0
    ds_add_rtn_u32 v68, v58, v88 offset:0
    ds_add_rtn_u32 v69, v59, v88 offset:0
    ds_add_rtn_u32 v70, v60, v88 offset:0
    ds_add_rtn_u32 v71, v61, v88 offset:0
    s_waitcnt vmcnt(3)
    v_lshlrev_b32_sdwa v62, 2, v12 dst_sel:DWORD dst_unused:UNUSED_PAD src0_sel:DWORD src1_sel:BYTE_0
    v_lshlrev_b32_sdwa v63, 2, v13 dst_sel:DWORD dst_unused:UNUSED_PAD src0_sel:DWORD src1_sel:BYTE_0
    ds_add_rtn_u32 v72, v62, v88 offset:0
    ds_add_rtn_u32 v73, v63, v88 offset:0
    s_lshr_b32 s35, s2, 3
    s_mul_i32 s35, s35, 5
    s_add_u32 s35, s35, s15
    s_lshl_b32 s35, s35, 10
    s_cmp_ge_u32 s35, 163840
    s_cselect_b32 s34, 163840, 0
    s_sub_u32 s35, s35, s34
    s_min_u32 s34, s35, 159744
    s_add_u32 m0, s34, 2048
    s_add_u32 s34, s34, 160000
    buffer_load_dwordx4 v89, s[36:39], s34 offen lds
    s_add_u32 s35, s35, 16384
    s_cmp_ge_u32 s35, 163840
    s_cselect_b32 s34, 163840, 0
    s_sub_u32 s35, s35, s34
    s_min_u32 s34, s35, 159744
    s_add_u32 m0, s34, 2048
    s_add_u32 s34, s34, 160000
    buffer_load_dwordx4 v89, s[36:39], s34 offen lds
    s_add_u32 s35, s35, 16384
    s_cmp_ge_u32 s35, 163840
    s_cselect_b32 s34, 163840, 0
    s_sub_u32 s35, s35, s34
    s_min_u32 s34, s35, 159744
    s_add_u32 m0, s34, 2048
    s_add_u32 s34, s34, 160000
    buffer_load_dwordx4 v89, s[36:39], s34 offen lds
    s_add_u32 s35, s35, 16384
    s_cmp_ge_u32 s35, 163840
    s_cselect_b32 s34, 163840, 0
    s_sub_u32 s35, s35, s34
    s_min_u32 s34, s35, 159744
    s_add_u32 m0, s34, 2048
    s_add_u32 s34, s34, 160000
    buffer_load_dwordx4 v89, s[36:39], s34 offen lds
    s_add_u32 s35, s35, 16384
    s_cmp_ge_u32 s35, 163840
    s_cselect_b32 s34, 163840, 0
    s_sub_u32 s35, s35, s34
    s_min_u32 s34, s35, 159744
    s_add_u32 m0, s34, 2048
    s_add_u32 s34, s34, 160000
    buffer_load_dwordx4 v89, s[36:39], s34 offen lds
    s_add_u32 s35, s35, 16384
    s_cmp_ge_u32 s35, 163840
    s_cselect_b32 s34, 163840, 0
    s_sub_u32 s35, s35, s34
    s_min_u32 s34, s35, 159744
    s_add_u32 m0, s34, 2048
    s_add_u32 s34, s34, 160000
    buffer_load_dwordx4 v89, s[36:39], s34 offen lds
    s_add_u32 s35, s35, 16384
    s_cmp_ge_u32 s35, 163840
    s_cselect_b32 s34, 163840, 0
    s_sub_u32 s35, s35, s34
    s_min_u32 s34, s35, 159744
    s_add_u32 m0, s34, 2048
    s_add_u32 s34, s34, 160000
    buffer_load_dwordx4 v89, s[36:39], s34 offen lds
    s_add_u32 s35, s35, 16384
    s_cmp_ge_u32 s35, 163840
    s_cselect_b32 s34, 163840, 0
    s_sub_u32 s35, s35, s34
    s_min_u32 s34, s35, 159744
    s_add_u32 m0, s34, 2048
    s_add_u32 s34, s34, 160000
    buffer_load_dwordx4 v89, s[36:39], s34 offen lds
    s_add_u32 s35, s35, 16384
    s_cmp_ge_u32 s35, 163840
    s_cselect_b32 s34, 163840, 0
    s_sub_u32 s35, s35, s34
    s_min_u32 s34, s35, 159744
    s_add_u32 m0, s34, 2048
    s_add_u32 s34, s34, 160000
    buffer_load_dwordx4 v89, s[36:39], s34 offen lds
    s_add_u32 s35, s35, 16384
    s_cmp_ge_u32 s35, 163840
    s_cselect_b32 s34, 163840, 0
    s_sub_u32 s35, s35, s34
    s_min_u32 s34, s35, 159744
    s_add_u32 m0, s34, 2048
    s_add_u32 s34, s34, 160000
    buffer_load_dwordx4 v89, s[36:39], s34 offen lds
    v_lshrrev_b32 v90, 10, v4
    v_bfe_u32 v91, v4, 8, 3
    v_and_or_b32 v90, v90, s46, v34
    v_lshl_or_b32 v34, v91, 26, v90
    v_lshrrev_b32 v90, 10, v5
    v_bfe_u32 v91, v5, 8, 3
    v_and_or_b32 v90, v90, s46, v36
    v_lshl_or_b32 v36, v91, 26, v90
    v_lshrrev_b32 v90, 10, v6
    v_bfe_u32 v91, v6, 8, 3
    v_and_or_b32 v90, v90, s46, v38
    v_lshl_or_b32 v38, v91, 26, v90
    v_lshrrev_b32 v90, 10, v7
    v_bfe_u32 v91, v7, 8, 3
    v_and_or_b32 v90, v90, s46, v40
    v_lshl_or_b32 v40, v91, 26, v90
    v_lshrrev_b32 v90, 10, v8
    v_bfe_u32 v91, v8, 8, 3
    v_and_or_b32 v90, v90, s46, v42
    v_lshl_or_b32 v42, v91, 26, v90
    v_lshrrev_b32 v90, 10, v9
    v_bfe_u32 v91, v9, 8, 3
    v_and_or_b32 v90, v90, s46, v44
    v_lshl_or_b32 v44, v91, 26, v90
    v_lshrrev_b32 v90, 10, v10
    v_bfe_u32 v91, v10, 8, 3
    v_and_or_b32 v90, v90, s46, v46
    v_lshl_or_b32 v46, v91, 26, v90
    v_lshrrev_b32 v90, 10, v11
    v_bfe_u32 v91, v11, 8, 3
    v_and_or_b32 v90, v90, s46, v48
    v_lshl_or_b32 v48, v91, 26, v90
    v_lshrrev_b32 v90, 10, v12
    v_bfe_u32 v91, v12, 8, 3
    v_and_or_b32 v90, v90, s46, v50
    v_lshl_or_b32 v50, v91, 26, v90
    v_lshrrev_b32 v90, 10, v13
    v_bfe_u32 v91, v13, 8, 3
    v_and_or_b32 v90, v90, s46, v52
    v_lshl_or_b32 v52, v91, 26, v90
    s_waitcnt vmcnt(12)
    v_and_b32 v35, 0xffff, v28
    v_lshrrev_b32 v37, 16, v28
    v_and_b32 v39, 0xffff, v29
    v_lshrrev_b32 v41, 16, v29
    s_waitcnt vmcnt(11)
    v_and_b32 v43, 0xffff, v30
    v_lshrrev_b32 v45, 16, v30
    v_and_b32 v47, 0xffff, v31
    v_lshrrev_b32 v49, 16, v31
    s_waitcnt vmcnt(10)
    v_and_b32 v51, 0xffff, v32
    v_lshrrev_b32 v53, 16, v32
    s_waitcnt lgkmcnt(0)
    s_barrier
    ds_read_b128 v[4:7], v89 offset:0
    s_waitcnt lgkmcnt(0)
    v_add_u32 v8, v4, v5
    v_add3_u32 v8, v8, v6, v7
    v_mov_b32 v9, v8
    s_nop 1
    v_add_u32_dpp v9, v9, v9 row_shr:1 row_mask:0xf bank_mask:0xf bound_ctrl:0
    s_nop 1
    v_add_u32_dpp v9, v9, v9 row_shr:2 row_mask:0xf bank_mask:0xf bound_ctrl:0
    s_nop 1
    v_add_u32_dpp v9, v9, v9 row_shr:4 row_mask:0xf bank_mask:0xf bound_ctrl:0
    s_nop 1
    v_add_u32_dpp v9, v9, v9 row_shr:8 row_mask:0xf bank_mask:0xf bound_ctrl:0
    s_nop 1
    v_add_u32_dpp v9, v9, v9 row_bcast:15 row_mask:0xa bank_mask:0xf
    s_nop 1
    v_add_u32_dpp v9, v9, v9 row_bcast:31 row_mask:0xc bank_mask:0xf
    v_sub_u32 v10, v9, v8
    v_add_u32 v11, v10, v4
    v_add_u32 v12, v11, v5
    v_add_u32 v13, v12, v6
    ds_write_b128 v89, v[10:13] offset:1024
    ds_read_b32 v54, v54 offset:1024
    ds_read_b32 v55, v55 offset:1024
    ds_read_b32 v56, v56 offset:1024
    ds_read_b32 v57, v57 offset:1024
    ds_read_b32 v58, v58 offset:1024
    ds_read_b32 v59, v59 offset:1024
    ds_read_b32 v60, v60 offset:1024
    ds_read_b32 v61, v61 offset:1024
    ds_read_b32 v62, v62 offset:1024
    ds_read_b32 v63, v63 offset:1024
    v_lshl_or_b32 v84, v4, 16, v10
    v_lshl_or_b32 v85, v5, 16, v11
    v_lshl_or_b32 v86, v6, 16, v12
    v_lshl_or_b32 v87, v7, 16, v13
    s_waitcnt lgkmcnt(0)
    v_add_lshl_u32 v54, v54, v64, 3
    v_add_lshl_u32 v55, v55, v65, 3
    v_add_lshl_u32 v56, v56, v66, 3
    v_add_lshl_u32 v57, v57, v67, 3
    v_add_lshl_u32 v58, v58, v68, 3
    v_add_lshl_u32 v59, v59, v69, 3
    v_add_lshl_u32 v60, v60, v70, 3
    v_add_lshl_u32 v61, v61, v71, 3
    v_add_lshl_u32 v62, v62, v72, 3
    v_add_lshl_u32 v63, v63, v73, 3
    s_waitcnt vmcnt(0)
    s_barrier
    v_cmpx_le_u32 vcc, s47, v16
    v_subrev_u32 v16, s47, v16
    ds_read_u16 v74, v16 offset:2048
    s_mov_b64 exec, -1
    v_cmpx_le_u32 vcc, s47, v17
    v_subrev_u32 v17, s47, v17
    ds_read_u16 v75, v17 offset:2048
    s_mov_b64 exec, -1
    v_cmpx_le_u32 vcc, s47, v18
    v_subrev_u32 v18, s47, v18
    ds_read_u16 v76, v18 offset:2048
    s_mov_b64 exec, -1
    v_cmpx_le_u32 vcc, s47, v19
    v_subrev_u32 v19, s47, v19
    ds_read_u16 v77, v19 offset:2048
    s_mov_b64 exec, -1
    v_cmpx_le_u32 vcc, s47, v20
    v_subrev_u32 v20, s47, v20
    ds_read_u16 v78, v20 offset:2048
    s_mov_b64 exec, -1
    v_cmpx_le_u32 vcc, s47, v21
    v_subrev_u32 v21, s47, v21
    ds_read_u16 v79, v21 offset:2048
    s_mov_b64 exec, -1
    v_cmpx_le_u32 vcc, s47, v22
    v_subrev_u32 v22, s47, v22
    ds_read_u16 v80, v22 offset:2048
    s_mov_b64 exec, -1
    v_cmpx_le_u32 vcc, s47, v23
    v_subrev_u32 v23, s47, v23
    ds_read_u16 v81, v23 offset:2048
    s_mov_b64 exec, -1
    v_cmpx_le_u32 vcc, s47, v24
    v_subrev_u32 v24, s47, v24
    ds_read_u16 v82, v24 offset:2048
    s_mov_b64 exec, -1
    v_cmpx_le_u32 vcc, s47, v25
    v_subrev_u32 v25, s47, v25
    ds_read_u16 v83, v25 offset:2048
    s_mov_b64 exec, -1
    s_cmp_lg_u32 s15, 0
    s_cbranch_scc1 K1_notab
    s_lshl_b32 s35, s2, 10
    s_add_u32 s35, s35, 21495808
    buffer_store_dwordx4 v[84:87], v89, s[28:31], s35 offen sc1
K1_notab:
    s_waitcnt lgkmcnt(0)
    s_barrier
    v_lshl_or_b32 v35, v74, 16, v35
    ds_write_b64 v54, v[34:35] offset:2048
    v_lshl_or_b32 v37, v75, 16, v37
    ds_write_b64 v55, v[36:37] offset:2048
    v_lshl_or_b32 v39, v76, 16, v39
    ds_write_b64 v56, v[38:39] offset:2048
    v_lshl_or_b32 v41, v77, 16, v41
    ds_write_b64 v57, v[40:41] offset:2048
    v_lshl_or_b32 v43, v78, 16, v43
    ds_write_b64 v58, v[42:43] offset:2048
    v_lshl_or_b32 v45, v79, 16, v45
    ds_write_b64 v59, v[44:45] offset:2048
    v_lshl_or_b32 v47, v80, 16, v47
    ds_write_b64 v60, v[46:47] offset:2048
    v_lshl_or_b32 v49, v81, 16, v49
    ds_write_b64 v61, v[48:49] offset:2048
    v_lshl_or_b32 v51, v82, 16, v51
    ds_write_b64 v62, v[50:51] offset:2048
    v_lshl_or_b32 v53, v83, 16, v53
    ds_write_b64 v63, v[52:53] offset:2048
    s_waitcnt lgkmcnt(0)
    s_barrier
    s_mul_i32 s12, s2, 81920
    v_add_u32 v2, 0x8000, v1
    v_add_u32 v3, 0x10000, v1
    ds_read_b128 v[4:7], v1 offset:2048
    ds_read_b128 v[8:11], v1 offset:18432
    ds_read_b128 v[12:15], v2 offset:2048
    ds_read_b128 v[16:19], v2 offset:18432
    ds_read_b128 v[20:23], v3 offset:2048
    s_waitcnt lgkmcnt(4)
    buffer_store_dwordx4 v[4:7], v1, s[28:31], s12 offen sc1
    s_add_u32 s12, s12, 16384
    s_waitcnt lgkmcnt(3)
    buffer_store_dwordx4 v[8:11], v1, s[28:31], s12 offen sc1
    s_add_u32 s12, s12, 16384
    s_waitcnt lgkmcnt(2)
    buffer_store_dwordx4 v[12:15], v1, s[28:31], s12 offen sc1
    s_add_u32 s12, s12, 16384
    s_waitcnt lgkmcnt(1)
    buffer_store_dwordx4 v[16:19], v1, s[28:31], s12 offen sc1
    s_add_u32 s12, s12, 16384
    s_waitcnt lgkmcnt(0)
    buffer_store_dwordx4 v[20:23], v1, s[28:31], s12 offen sc1
K1_end:
    s_endpgm
.p2align 8
.globl sweep_kernel
.type sweep_kernel,@function
sweep_kernel:
    s_load_dwordx2 s[12:13], s[0:1], 88
    s_load_dwordx4 s[80:83], s[0:1], 0
    s_load_dwordx2 s[84:85], s[0:1], 40
    s_load_dwordx4 s[88:91], s[0:1], 48
    s_load_dwordx4 s[92:95], s[0:1], 64
    s_cmp_ge_u32 s2, 256
    s_cbranch_scc1 K3_end
    v_lshrrev_b32 v10, 6, v0
    v_and_b32 v11, 63, v0
    s_and_b32 s16, s2, 7
    s_lshl_b32 s16, s16, 5
    s_lshr_b32 s32, s2, 3
    s_add_u32 s16, s16, s32
    v_lshl_add_u32 v1, v10, 5, v11
    v_mov_b32 v6, 0
    v_lshlrev_b32 v11, 10, v1
    s_lshl_b32 s32, s16, 2
    s_add_u32 s32, s32, 21495808
    s_mov_b32 s14, 21751808
    s_mov_b32 s15, 0x20000
    s_bfm_b64 exec, 32, 0
    s_waitcnt lgkmcnt(0)
    buffer_load_dword v6, v11, s[12:15], s32 offen
    s_mov_b64 exec, -1
    v_readfirstlane_b32 s17, v10
    v_lshlrev_b32 v10, 5, v0
    v_and_b32 v0, 63, v0
    v_mov_b32 v12, 0
    v_mov_b32 v13, 0
    v_mov_b32 v14, 0
    v_mov_b32 v15, 0
    ds_write_b128 v10, v[12:15] offset:4096
    ds_write_b128 v10, v[12:15] offset:4112
    v_and_b32 v16, 15, v0
    v_lshrrev_b32 v17, 4, v0
    v_lshl_add_u32 v16, v16, 2, v17
    v_lshlrev_b32 v16, 2, v16
    s_load_dwordx2 s[24:25], s[88:89], 0
    s_load_dword s34, s[84:85], 0
    s_mov_b32 s4, s90
    s_mov_b32 s5, s91
    s_mov_b32 s6, 768
    s_mov_b32 s7, 0x20000
    s_mov_b32 s8, s92
    s_mov_b32 s9, s93
    s_mov_b32 s10, 256
    s_mov_b32 s11, 0x20000
    s_mov_b32 s76, s82
    s_mov_b32 s77, s83
    s_mov_b32 s78, 320000
    s_mov_b32 s79, 0x20000
    buffer_load_dword v2, v16, s[4:7], 0 offen
    buffer_load_dword v4, v16, s[4:7], 0 offen offset:256
    buffer_load_dword v3, v16, s[4:7], 0 offen offset:512
    buffer_load_dword v5, v16, s[8:11], 0 offen
    s_mov_b32 s4, s80
    s_mov_b32 s5, s81
    s_mov_b32 s6, 40960000
    s_mov_b32 s7, 0x20000
    s_mov_b32 s8, s94
    s_mov_b32 s9, s95
    s_mov_b32 s10, 40960000
    s_mov_b32 s11, 0x20000
    s_mov_b32 s27, 0x3e22f900
    s_mov_b32 s28, 0x36036e4e
    s_mov_b32 s29, 0x03ffff00
    s_mov_b32 s30, 0xc000
    s_mov_b32 s32, 81920
    v_cmp_gt_u32 vcc, 250, v1
    v_mul_lo_u32 v1, v1, s32
    s_mov_b32 s18, 0
    s_mov_b32 s19, 0
    s_mov_b32 s20, 0
    s_lshl_b32 s32, s17, 8
    s_add_u32 s32, s32, s16
    s_lshl_b32 s32, s32, 8
    s_lshl_b32 s33, s17, 26
    s_or_b32 s32, s32, s33
    s_bitset1_b32 s32, 31
    s_mov_b32 s33, 524290
    v_mul_lo_u32 v78, v0, s33
    v_add_u32 v78, s32, v78
    v_add_u32 v80, 20971600, v78
    s_mov_b32 s74, 40
    s_cmp_eq_u32 s17, 0
    s_cselect_b32 s75, 39, 38
    v_mov_b32 v98, 0
    v_mov_b32 v99, 0
    v_mov_b32 v100, 0
    v_mov_b32 v101, 0
    v_mov_b32 v102, 0
    v_mov_b32 v103, 0
    v_mov_b32 v104, 0
    v_mov_b32 v105, 0
    v_mov_b32 v106, 0
    v_mov_b32 v107, 0
    v_mov_b32 v108, 0
    v_mov_b32 v109, 0
    v_mov_b32 v110, 0
    v_mov_b32 v111, 0
    v_mov_b32 v112, 0
    v_mov_b32 v113, 0
    v_mov_b32 v114, 0
    v_mov_b32 v115, 0
    v_mov_b32 v116, 0
    v_mov_b32 v117, 0
    v_mov_b32 v118, 0
    v_mov_b32 v119, 0
    v_mov_b32 v120, 0
    v_mov_b32 v121, 0
    v_mov_b32 v122, 0
    v_mov_b32 v123, 0
    v_mov_b32 v124, 0
    v_mov_b32 v125, 0
    v_mov_b32 v126, 0
    v_mov_b32 v127, 0
    v_mov_b32 v128, 0
    v_mov_b32 v129, 0
    v_mov_b32 v130, 0
    v_mov_b32 v131, 0
    v_mov_b32 v132, 0
    v_mov_b32 v133, 0
    v_mov_b32 v134, 0
    v_mov_b32 v135, 0
    v_mov_b32 v136, 0
    v_mov_b32 v137, 0
    v_mov_b32 v138, 0
    v_mov_b32 v139, 0
    v_mov_b32 v140, 0
    v_mov_b32 v141, 0
    v_mov_b32 v142, 0
    v_mov_b32 v143, 0
    v_mov_b32 v144, 0
    v_mov_b32 v145, 0
    v_mov_b32 v146, 0
    v_mov_b32 v147, 0
    v_mov_b32 v148, 0
    v_mov_b32 v149, 0
    v_mov_b32 v150, 0
    v_mov_b32 v151, 0
    v_mov_b32 v152, 0
    v_mov_b32 v153, 0
    v_mov_b32 v154, 0
    v_mov_b32 v155, 0
    v_mov_b32 v156, 0
    v_mov_b32 v157, 0
    v_mov_b32 v158, 0
    v_mov_b32 v159, 0
    v_mov_b32 v160, 0
    v_mov_b32 v161, 0
    v_mov_b32 v162, 0
    v_mov_b32 v163, 0
    v_mov_b32 v164, 0
    v_mov_b32 v165, 0
    v_mov_b32 v166, 0
    v_mov_b32 v167, 0
    v_mov_b32 v168, 0
    v_mov_b32 v169, 0
    v_mov_b32 v170, 0
    v_mov_b32 v171, 0
    v_mov_b32 v172, 0
    v_mov_b32 v173, 0
    v_mov_b32 v174, 0
    v_mov_b32 v175, 0
    v_mov_b32 v176, 0
    v_mov_b32 v177, 0
    v_mov_b32 v178, 0
    v_mov_b32 v179, 0
    v_mov_b32 v180, 0
    v_mov_b32 v181, 0
    v_mov_b32 v182, 0
    v_mov_b32 v183, 0
    v_mov_b32 v184, 0
    v_mov_b32 v185, 0
    v_mov_b32 v186, 0
    v_mov_b32 v187, 0
    v_mov_b32 v188, 0
    v_mov_b32 v189, 0
    v_mov_b32 v190, 0
    v_mov_b32 v191, 0
    v_mov_b32 v192, 0
    v_mov_b32 v193, 0
    v_mov_b32 v194, 0
    v_mov_b32 v195, 0
    v_mov_b32 v196, 0
    v_mov_b32 v197, 0
    v_mov_b32 v198, 0
    v_mov_b32 v199, 0
    v_mov_b32 v200, 0
    v_mov_b32 v201, 0
    v_mov_b32 v202, 0
    v_mov_b32 v203, 0
    v_mov_b32 v204, 0
    v_mov_b32 v205, 0
    v_mov_b32 v206, 0
    v_mov_b32 v207, 0
    v_mov_b32 v208, 0
    v_mov_b32 v209, 0
    v_mov_b32 v210, 0
    v_mov_b32 v211, 0
    v_mov_b32 v212, 0
    v_mov_b32 v213, 0
    v_mov_b32 v214, 0
    v_mov_b32 v215, 0
    v_mov_b32 v216, 0
    v_mov_b32 v217, 0
    v_mov_b32 v218, 0
    v_mov_b32 v219, 0
    v_mov_b32 v220, 0
    v_mov_b32 v221, 0
    v_mov_b32 v222, 0
    v_mov_b32 v223, 0
    v_mov_b32 v224, 0
    v_mov_b32 v225, 0
    v_mov_b32 v226, 0
    v_mov_b32 v227, 0
    v_mov_b32 v228, 0
    v_mov_b32 v229, 0
    v_mov_b32 v230, 0
    v_mov_b32 v231, 0
    v_mov_b32 v232, 0
    v_mov_b32 v233, 0
    v_mov_b32 v234, 0
    v_mov_b32 v235, 0
    v_mov_b32 v236, 0
    v_mov_b32 v237, 0
    v_mov_b32 v238, 0
    v_mov_b32 v239, 0
    v_mov_b32 v240, 0
    v_mov_b32 v241, 0
    v_mov_b32 v242, 0
    v_mov_b32 v243, 0
    v_mov_b32 v244, 0
    v_mov_b32 v245, 0
    v_mov_b32 v246, 0
    v_mov_b32 v247, 0
    v_mov_b32 v248, 0
    v_mov_b32 v249, 0
    v_mov_b32 v250, 0
    v_mov_b32 v251, 0
    v_mov_b32 v252, 0
    v_mov_b32 v253, 0
    v_mov_b32 v254, 0
    v_mov_b32 v255, 0
    s_waitcnt vmcnt(4)
    v_cndmask_b32 v6, 0, v6, vcc
    v_and_b32 v11, 0xffff, v6
    v_lshl_add_u32 v1, v11, 3, v1
    v_lshrrev_b32 v6, 16, v6
K3_round:
    v_lshlrev_b32 v7, 3, v0
    v_mov_b32 v8, 1
    v_mov_b32 v94, v6
    v_mov_b32 v95, v1
    v_cmp_lt_u32 vcc, 63, v6
    s_or_b32 s32, vcc_lo, s18
    s_cbranch_scc1 K3_long
    s_mov_b32 s18, 32
K3_listed:
    v_readlane_b32 s36, v95, 0
    v_readlane_b32 s37, v95, 1
    v_readlane_b32 s38, v95, 2
    v_readlane_b32 s40, v94, 0
    v_readlane_b32 s41, v94, 1
    v_readlane_b32 s42, v94, 2
    s_max_u32 s33, s40, 1
    s_bfm_b64 exec, s33, 0
    buffer_load_dwordx2 v[10:11], v7, s[12:15], s36 offen
    s_max_u32 s33, s41, 1
    s_bfm_b64 exec, s33, 0
    buffer_load_dwordx2 v[12:13], v7, s[12:15], s37 offen
    s_max_u32 s33, s42, 1
    s_bfm_b64 exec, s33, 0
    buffer_load_dwordx2 v[14:15], v7, s[12:15], s38 offen
    v_readlane_b32 s36, v95, 3
    v_readlane_b32 s37, v95, 4
    v_readlane_b32 s38, v95, 5
    v_readlane_b32 s43, v94, 3
    v_readlane_b32 s44, v94, 4
    v_readlane_b32 s45, v94, 5
    s_max_u32 s33, s43, 1
    s_bfm_b64 exec, s33, 0
    buffer_load_dwordx2 v[16:17], v7, s[12:15], s36 offen
    s_max_u32 s33, s44, 1
    s_bfm_b64 exec, s33, 0
    buffer_load_dwordx2 v[18:19], v7, s[12:15], s37 offen
    s_max_u32 s33, s45, 1
    s_bfm_b64 exec, s33, 0
    buffer_load_dwordx2 v[20:21], v7, s[12:15], s38 offen
    s_mov_b64 exec, -1
    s_mul_i32 s32, s17, 2280
    v_min_u32 v83, 20, v0
    v_mul_u32_u24 v83, 114, v83
    v_add_u32 v83, s32, v83
    s_lshl_b32 s32, s17, 7
    v_lshl_add_u32 v82, v0, 2, s32
    s_bfm_b64 exec, 32, 0
    ds_write_b32 v82, v83 offset:0
    s_mov_b64 exec, -1
    v_cmp_le_u32 vcc, s18, v0
    v_cmp_lt_u32 s[32:33], 0, v6
    s_and_b32 s32, s32, vcc_lo
    s_or_b32 s32, s32, s19
    s_waitcnt lgkmcnt(0)
    s_barrier
    s_cmp_lg_u32 s32, 0
    s_cbranch_scc1 K3_more
K3_nomore:
    v_readlane_b32 s36, v95, 6
    v_readlane_b32 s37, v95, 7
    v_readlane_b32 s38, v95, 8
    v_readlane_b32 s46, v94, 6
    v_readlane_b32 s47, v94, 7
    v_readlane_b32 s48, v94, 8
    s_max_u32 s33, s46, 1
    s_bfm_b64 exec, s33, 0
    buffer_load_dwordx2 v[22:23], v7, s[12:15], s36 offen
    s_max_u32 s33, s47, 1
    s_bfm_b64 exec, s33, 0
    buffer_load_dwordx2 v[24:25], v7, s[12:15], s37 offen
    s_max_u32 s33, s48, 1
    s_bfm_b64 exec, s33, 0
    buffer_load_dwordx2 v[26:27], v7, s[12:15], s38 offen
    v_readlane_b32 s36, v95, 9
    v_readlane_b32 s37, v95, 10
    v_readlane_b32 s38, v95, 11
    v_readlane_b32 s49, v94, 9
    v_readlane_b32 s50, v94, 10
    v_readlane_b32 s51, v94, 11
    s_max_u32 s33, s49, 1
    s_bfm_b64 exec, s33, 0
    buffer_load_dwordx2 v[28:29], v7, s[12:15], s36 offen
    s_max_u32 s33, s50, 1
    s_bfm_b64 exec, s33, 0
    buffer_load_dwordx2 v[30:31], v7, s[12:15], s37 offen
    s_max_u32 s33, s51, 1
    s_bfm_b64 exec, s33, 0
    buffer_load_dwordx2 v[32:33], v7, s[12:15], s38 offen
    s_mov_b64 exec, -1
    s_waitcnt vmcnt(11)
    v_lshrrev_b32 v82, 19, v10
    v_and_b32 v82, 1020, v82
    s_waitcnt vmcnt(10)
    v_lshrrev_b32 v83, 19, v12
    v_and_b32 v83, 1020, v83
    s_waitcnt vmcnt(9)
    v_lshrrev_b32 v84, 19, v14
    v_and_b32 v84, 1020, v84
    s_waitcnt vmcnt(8)
    v_lshrrev_b32 v85, 19, v16
    v_and_b32 v85, 1020, v85
    s_waitcnt vmcnt(7)
    v_lshrrev_b32 v86, 19, v18
    v_and_b32 v86, 1020, v86
    s_waitcnt vmcnt(6)
    v_lshrrev_b32 v87, 19, v20
    v_and_b32 v87, 1020, v87
    s_bfm_b64 exec, s40, 0
    ds_add_rtn_u32 v82, v82, v8 offset:0
    s_bfm_b64 exec, s41, 0
    ds_add_rtn_u32 v83, v83, v8 offset:0
    s_bfm_b64 exec, s42, 0
    ds_add_rtn_u32 v84, v84, v8 offset:0
    s_bfm_b64 exec, s43, 0
    ds_add_rtn_u32 v85, v85, v8 offset:0
    s_bfm_b64 exec, s44, 0
    ds_add_rtn_u32 v86, v86, v8 offset:0
    s_bfm_b64 exec, s45, 0
    ds_add_rtn_u32 v87, v87, v8 offset:0
    s_mov_b64 exec, -1
    v_readlane_b32 s36, v95, 12
    v_readlane_b32 s37, v95, 13
    v_readlane_b32 s38, v95, 14
    v_readlane_b32 s52, v94, 12
    v_readlane_b32 s53, v94, 13
    v_readlane_b32 s54, v94, 14
    s_max_u32 s33, s52, 1
    s_bfm_b64 exec, s33, 0
    buffer_load_dwordx2 v[34:35], v7, s[12:15], s36 offen
    s_max_u32 s33, s53, 1
    s_bfm_b64 exec, s33, 0
    buffer_load_dwordx2 v[36:37], v7, s[12:15], s37 offen
    s_max_u32 s33, s54, 1
    s_bfm_b64 exec, s33, 0
    buffer_load_dwordx2 v[38:39], v7, s[12:15], s38 offen
    v_readlane_b32 s36, v95, 15
    v_readlane_b32 s37, v95, 16
    v_readlane_b32 s38, v95, 17
    v_readlane_b32 s55, v94, 15
    v_readlane_b32 s56, v94, 16
    v_readlane_b32 s57, v94, 17
    s_max_u32 s33, s55, 1
    s_bfm_b64 exec, s33, 0
    buffer_load_dwordx2 v[40:41], v7, s[12:15], s36 offen
    s_max_u32 s33, s56, 1
    s_bfm_b64 exec, s33, 0
    buffer_load_dwordx2 v[42:43], v7, s[12:15], s37 offen
    s_max_u32 s33, s57, 1
    s_bfm_b64 exec, s33, 0
    buffer_load_dwordx2 v[44:45], v7, s[12:15], s38 offen
    s_mov_b64 exec, -1
    s_waitcnt vmcnt(11)
    v_lshrrev_b32 v88, 19, v22
    v_and_b32 v88, 1020, v88
    s_waitcnt vmcnt(10)
    v_lshrrev_b32 v89, 19, v24
    v_and_b32 v89, 1020, v89
    s_waitcnt vmcnt(9)
    v_lshrrev_b32 v90, 19, v26
    v_and_b32 v90, 1020, v90
    s_waitcnt vmcnt(8)
    v_lshrrev_b32 v91, 19, v28
    v_and_b32 v91, 1020, v91
    s_waitcnt vmcnt(7)
    v_lshrrev_b32 v92, 19, v30
    v_and_b32 v92, 1020, v92
    s_waitcnt vmcnt(6)
    v_lshrrev_b32 v93, 19, v32
    v_and_b32 v93, 1020, v93
    s_waitcnt lgkmcnt(0)
    s_bfm_b64 exec, s46, 0
    ds_add_rtn_u32 v88, v88, v8 offset:0
    s_bfm_b64 exec, s47, 0
    ds_add_rtn_u32 v89, v89, v8 offset:0
    s_bfm_b64 exec, s48, 0
    ds_add_rtn_u32 v90, v90, v8 offset:0
    s_bfm_b64 exec, s49, 0
    ds_add_rtn_u32 v91, v91, v8 offset:0
    s_bfm_b64 exec, s50, 0
    ds_add_rtn_u32 v92, v92, v8 offset:0
    s_bfm_b64 exec, s51, 0
    ds_add_rtn_u32 v93, v93, v8 offset:0
    s_mov_b64 exec, -1
    v_lshlrev_b32 v82, 3, v82
    v_lshlrev_b32 v83, 3, v83
    v_lshlrev_b32 v84, 3, v84
    v_lshlrev_b32 v85, 3, v85
    v_lshlrev_b32 v86, 3, v86
    v_lshlrev_b32 v87, 3, v87
    s_bfm_b64 exec, s40, 0
    ds_write_b64 v82, v[10:11] offset:16384
    s_bfm_b64 exec, s41, 0
    ds_write_b64 v83, v[12:13] offset:16384
    s_bfm_b64 exec, s42, 0
    ds_write_b64 v84, v[14:15] offset:16384
    s_bfm_b64 exec, s43, 0
    ds_write_b64 v85, v[16:17] offset:16384
    s_bfm_b64 exec, s44, 0
    ds_write_b64 v86, v[18:19] offset:16384
    s_bfm_b64 exec, s45, 0
    ds_write_b64 v87, v[20:21] offset:16384
    s_mov_b64 exec, -1
    v_readlane_b32 s36, v95, 18
    v_readlane_b32 s37, v95, 19
    v_readlane_b32 s38, v95, 20
    v_readlane_b32 s58, v94, 18
    v_readlane_b32 s59, v94, 19
    v_readlane_b32 s60, v94, 20
    s_max_u32 s33, s58, 1
    s_bfm_b64 exec, s33, 0
    buffer_load_dwordx2 v[46:47], v7, s[12:15], s36 offen
    s_max_u32 s33, s59, 1
    s_bfm_b64 exec, s33, 0
    buffer_load_dwordx2 v[48:49], v7, s[12:15], s37 offen
    s_max_u32 s33, s60, 1
    s_bfm_b64 exec, s33, 0
    buffer_load_dwordx2 v[50:51], v7, s[12:15], s38 offen
    v_readlane_b32 s36, v95, 21
    v_readlane_b32 s37, v95, 22
    v_readlane_b32 s38, v95, 23
    v_readlane_b32 s61, v94, 21
    v_readlane_b32 s62, v94, 22
    v_readlane_b32 s63, v94, 23
    s_max_u32 s33, s61, 1
    s_bfm_b64 exec, s33, 0
    buffer_load_dwordx2 v[52:53], v7, s[12:15], s36 offen
    s_max_u32 s33, s62, 1
    s_bfm_b64 exec, s33, 0
    buffer_load_dwordx2 v[54:55], v7, s[12:15], s37 offen
    s_max_u32 s33, s63, 1
    s_bfm_b64 exec, s33, 0
    buffer_load_dwordx2 v[56:57], v7, s[12:15], s38 offen
    s_mov_b64 exec, -1
    s_waitcnt vmcnt(11)
    v_lshrrev_b32 v82, 19, v34
    v_and_b32 v82, 1020, v82
    s_waitcnt vmcnt(10)
    v_lshrrev_b32 v83, 19, v36
    v_and_b32 v83, 1020, v83
    s_waitcnt vmcnt(9)
    v_lshrrev_b32 v84, 19, v38
    v_and_b32 v84, 1020, v84
    s_waitcnt vmcnt(8)
    v_lshrrev_b32 v85, 19, v40
    v_and_b32 v85, 1020, v85
    s_waitcnt vmcnt(7)
    v_lshrrev_b32 v86, 19, v42
    v_and_b32 v86, 1020, v86
    s_waitcnt vmcnt(6)
    v_lshrrev_b32 v87, 19, v44
    v_and_b32 v87, 1020, v87
    s_waitcnt lgkmcnt(0)
    s_bfm_b64 exec, s52, 0
    ds_add_rtn_u32 v82, v82, v8 offset:0
    s_bfm_b64 exec, s53, 0
    ds_add_rtn_u32 v83, v83, v8 offset:0
    s_bfm_b64 exec, s54, 0
    ds_add_rtn_u32 v84, v84, v8 offset:0
    s_bfm_b64 exec, s55, 0
    ds_add_rtn_u32 v85, v85, v8 offset:0
    s_bfm_b64 exec, s56, 0
    ds_add_rtn_u32 v86, v86, v8 offset:0
    s_bfm_b64 exec, s57, 0
    ds_add_rtn_u32 v87, v87, v8 offset:0
    s_mov_b64 exec, -1
    v_lshlrev_b32 v88, 3, v88
    v_lshlrev_b32 v89, 3, v89
    v_lshlrev_b32 v90, 3, v90
    v_lshlrev_b32 v91, 3, v91
    v_lshlrev_b32 v92, 3, v92
    v_lshlrev_b32 v93, 3, v93
    s_bfm_b64 exec, s46, 0
    ds_write_b64 v88, v[22:23] offset:16384
    s_bfm_b64 exec, s47, 0
    ds_write_b64 v89, v[24:25] offset:16384
    s_bfm_b64 exec, s48, 0
    ds_write_b64 v90, v[26:27] offset:16384
    s_bfm_b64 exec, s49, 0
    ds_write_b64 v91, v[28:29] offset:16384
    s_bfm_b64 exec, s50, 0
    ds_write_b64 v92, v[30:31] offset:16384
    s_bfm_b64 exec, s51, 0
    ds_write_b64 v93, v[32:33] offset:16384
    s_mov_b64 exec, -1
    v_readlane_b32 s36, v95, 24
    v_readlane_b32 s37, v95, 25
    v_readlane_b32 s38, v95, 26
    v_readlane_b32 s64, v94, 24
    v_readlane_b32 s65, v94, 25
    v_readlane_b32 s66, v94, 26
    s_max_u32 s33, s64, 1
    s_bfm_b64 exec, s33, 0
    buffer_load_dwordx2 v[58:59], v7, s[12:15], s36 offen
    s_max_u32 s33, s65, 1
    s_bfm_b64 exec, s33, 0
    buffer_load_dwordx2 v[60:61], v7, s[12:15], s37 offen
    s_max_u32 s33, s66, 1
    s_bfm_b64 exec, s33, 0
    buffer_load_dwordx2 v[62:63], v7, s[12:15], s38 offen
    v_readlane_b32 s36, v95, 27
    v_readlane_b32 s37, v95, 28
    v_readlane_b32 s38, v95, 29
    v_readlane_b32 s67, v94, 27
    v_readlane_b32 s68, v94, 28
    v_readlane_b32 s69, v94, 29
    s_max_u32 s33, s67, 1
    s_bfm_b64 exec, s33, 0
    buffer_load_dwordx2 v[64:65], v7, s[12:15], s36 offen
    s_max_u32 s33, s68, 1
    s_bfm_b64 exec, s33, 0
    buffer_load_dwordx2 v[66:67], v7, s[12:15], s37 offen
    s_max_u32 s33, s69, 1
    s_bfm_b64 exec, s33, 0
    buffer_load_dwordx2 v[68:69], v7, s[12:15], s38 offen
    s_mov_b64 exec, -1
    s_waitcnt vmcnt(11)
    v_lshrrev_b32 v88, 19, v46
    v_and_b32 v88, 1020, v88
    s_waitcnt vmcnt(10)
    v_lshrrev_b32 v89, 19, v48
    v_and_b32 v89, 1020, v89
    s_waitcnt vmcnt(9)
    v_lshrrev_b32 v90, 19, v50
    v_and_b32 v90, 1020, v90
    s_waitcnt vmcnt(8)
    v_lshrrev_b32 v91, 19, v52
    v_and_b32 v91, 1020, v91
    s_waitcnt vmcnt(7)
    v_lshrrev_b32 v92, 19, v54
    v_and_b32 v92, 1020, v92
    s_waitcnt vmcnt(6)
    v_lshrrev_b32 v93, 19, v56
    v_and_b32 v93, 1020, v93
    s_waitcnt lgkmcnt(0)
    s_bfm_b64 exec, s58, 0
    ds_add_rtn_u32 v88, v88, v8 offset:0
    s_bfm_b64 exec, s59, 0
    ds_add_rtn_u32 v89, v89, v8 offset:0
    s_bfm_b64 exec, s60, 0
    ds_add_rtn_u32 v90, v90, v8 offset:0
    s_bfm_b64 exec, s61, 0
    ds_add_rtn_u32 v91, v91, v8 offset:0
    s_bfm_b64 exec, s62, 0
    ds_add_rtn_u32 v92, v92, v8 offset:0
    s_bfm_b64 exec, s63, 0
    ds_add_rtn_u32 v93, v93, v8 offset:0
    s_mov_b64 exec, -1
    v_lshlrev_b32 v82, 3, v82
    v_lshlrev_b32 v83, 3, v83
    v_lshlrev_b32 v84, 3, v84
    v_lshlrev_b32 v85, 3, v85
    v_lshlrev_b32 v86, 3, v86
    v_lshlrev_b32 v87, 3, v87
    s_bfm_b64 exec, s52, 0
    ds_write_b64 v82, v[34:35] offset:16384
    s_bfm_b64 exec, s53, 0
    ds_write_b64 v83, v[36:37] offset:16384
    s_bfm_b64 exec, s54, 0
    ds_write_b64 v84, v[38:39] offset:16384
    s_bfm_b64 exec, s55, 0
    ds_write_b64 v85, v[40:41] offset:16384
    s_bfm_b64 exec, s56, 0
    ds_write_b64 v86, v[42:43] offset:16384
    s_bfm_b64 exec, s57, 0
    ds_write_b64 v87, v[44:45] offset:16384
    s_mov_b64 exec, -1
    v_readlane_b32 s36, v95, 30
    v_readlane_b32 s37, v95, 31
    v_readlane_b32 s38, v95, 32
    v_readlane_b32 s70, v94, 30
    v_readlane_b32 s71, v94, 31
    v_readlane_b32 s72, v94, 32
    s_max_u32 s33, s70, 1
    s_bfm_b64 exec, s33, 0
    buffer_load_dwordx2 v[70:71], v7, s[12:15], s36 offen
    s_max_u32 s33, s71, 1
    s_bfm_b64 exec, s33, 0
    buffer_load_dwordx2 v[72:73], v7, s[12:15], s37 offen
    s_max_u32 s33, s72, 1
    s_bfm_b64 exec, s33, 0
    buffer_load_dwordx2 v[74:75], v7, s[12:15], s38 offen
    v_readlane_b32 s36, v95, 33
    v_readlane_b32 s73, v94, 33
    s_max_u32 s33, s73, 1
    s_bfm_b64 exec, s33, 0
    s_nop 1
    buffer_load_dwordx2 v[76:77], v7, s[12:15], s36 offen
    s_mov_b64 exec, -1
    s_lshl_b32 s32, s17, 8
    s_add_u32 s32, s32, s16
    s_lshl_b32 s32, s32, 1
    s_add_u32 s33, s32, 163840
    v_lshlrev_b32 v9, 12, v0
    s_bfm_b64 exec, 40, 0
    buffer_load_ushort v79, v9, s[76:79], s32 offen
    buffer_load_ushort v81, v9, s[76:79], s33 offen
    s_mov_b64 exec, -1
    s_waitcnt vmcnt(11)
    v_lshrrev_b32 v82, 19, v58
    v_and_b32 v82, 1020, v82
    s_waitcnt vmcnt(10)
    v_lshrrev_b32 v83, 19, v60
    v_and_b32 v83, 1020, v83
    s_waitcnt vmcnt(9)
    v_lshrrev_b32 v84, 19, v62
    v_and_b32 v84, 1020, v84
    s_waitcnt vmcnt(8)
    v_lshrrev_b32 v85, 19, v64
    v_and_b32 v85, 1020, v85
    s_waitcnt vmcnt(7)
    v_lshrrev_b32 v86, 19, v66
    v_and_b32 v86, 1020, v86
    s_waitcnt vmcnt(6)
    v_lshrrev_b32 v87, 19, v68
    v_and_b32 v87, 1020, v87
    s_waitcnt lgkmcnt(0)
    s_bfm_b64 exec, s64, 0
    ds_add_rtn_u32 v82, v82, v8 offset:0
    s_bfm_b64 exec, s65, 0
    ds_add_rtn_u32 v83, v83, v8 offset:0
    s_bfm_b64 exec, s66, 0
    ds_add_rtn_u32 v84, v84, v8 offset:0
    s_bfm_b64 exec, s67, 0
    ds_add_rtn_u32 v85, v85, v8 offset:0
    s_bfm_b64 exec, s68, 0
    ds_add_rtn_u32 v86, v86, v8 offset:0
    s_bfm_b64 exec, s69, 0
    ds_add_rtn_u32 v87, v87, v8 offset:0
    s_mov_b64 exec, -1
    v_lshlrev_b32 v88, 3, v88
    v_lshlrev_b32 v89, 3, v89
    v_lshlrev_b32 v90, 3, v90
    v_lshlrev_b32 v91, 3, v91
    v_lshlrev_b32 v92, 3, v92
    v_lshlrev_b32 v93, 3, v93
    s_bfm_b64 exec, s58, 0
    ds_write_b64 v88, v[46:47] offset:16384
    s_bfm_b64 exec, s59, 0
    ds_write_b64 v89, v[48:49] offset:16384
    s_bfm_b64 exec, s60, 0
    ds_write_b64 v90, v[50:51] offset:16384
    s_bfm_b64 exec, s61, 0
    ds_write_b64 v91, v[52:53] offset:16384
    s_bfm_b64 exec, s62, 0
    ds_write_b64 v92, v[54:55] offset:16384
    s_bfm_b64 exec, s63, 0
    ds_write_b64 v93, v[56:57] offset:16384
    s_mov_b64 exec, -1
    s_waitcnt vmcnt(5)
    v_lshrrev_b32 v88, 19, v70
    v_and_b32 v88, 1020, v88
    s_waitcnt vmcnt(4)
    v_lshrrev_b32 v89, 19, v72
    v_and_b32 v89, 1020, v89
    s_waitcnt vmcnt(3)
    v_lshrrev_b32 v90, 19, v74
    v_and_b32 v90, 1020, v90
    s_waitcnt vmcnt(2)
    v_lshrrev_b32 v91, 19, v76
    v_and_b32 v91, 1020, v91
    v_lshrrev_b32 v92, 19, v78
    v_and_b32 v92, 1020, v92
    v_lshrrev_b32 v93, 19, v80
    v_and_b32 v93, 1020, v93
    s_waitcnt lgkmcnt(0)
    s_bfm_b64 exec, s70, 0
    ds_add_rtn_u32 v88, v88, v8 offset:0
    s_bfm_b64 exec, s71, 0
    ds_add_rtn_u32 v89, v89, v8 offset:0
    s_bfm_b64 exec, s72, 0
    ds_add_rtn_u32 v90, v90, v8 offset:0
    s_bfm_b64 exec, s73, 0
    ds_add_rtn_u32 v91, v91, v8 offset:0
    s_bfm_b64 exec, s74, 0
    ds_add_rtn_u32 v92, v92, v8 offset:0
    s_bfm_b64 exec, s75, 0
    ds_add_rtn_u32 v93, v93, v8 offset:0
    s_mov_b64 exec, -1
    v_lshlrev_b32 v82, 3, v82
    v_lshlrev_b32 v83, 3, v83
    v_lshlrev_b32 v84, 3, v84
    v_lshlrev_b32 v85, 3, v85
    v_lshlrev_b32 v86, 3, v86
    v_lshlrev_b32 v87, 3, v87
    s_bfm_b64 exec, s64, 0
    ds_write_b64 v82, v[58:59] offset:16384
    s_bfm_b64 exec, s65, 0
    ds_write_b64 v83, v[60:61] offset:16384
    s_bfm_b64 exec, s66, 0
    ds_write_b64 v84, v[62:63] offset:16384
    s_bfm_b64 exec, s67, 0
    ds_write_b64 v85, v[64:65] offset:16384
    s_bfm_b64 exec, s68, 0
    ds_write_b64 v86, v[66:67] offset:16384
    s_bfm_b64 exec, s69, 0
    ds_write_b64 v87, v[68:69] offset:16384
    s_mov_b64 exec, -1
    s_waitcnt lgkmcnt(0)
    v_lshlrev_b32 v88, 3, v88
    v_lshlrev_b32 v89, 3, v89
    v_lshlrev_b32 v90, 3, v90
    v_lshlrev_b32 v91, 3, v91
    v_lshlrev_b32 v92, 3, v92
    v_lshlrev_b32 v93, 3, v93
    s_waitcnt vmcnt(0)
    v_lshlrev_b32 v79, 16, v79
    v_lshlrev_b32 v81, 16, v81
    s_bfm_b64 exec, s70, 0
    ds_write_b64 v88, v[70:71] offset:16384
    s_bfm_b64 exec, s71, 0
    ds_write_b64 v89, v[72:73] offset:16384
    s_bfm_b64 exec, s72, 0
    ds_write_b64 v90, v[74:75] offset:16384
    s_bfm_b64 exec, s73, 0
    ds_write_b64 v91, v[76:77] offset:16384
    s_bfm_b64 exec, s74, 0
    ds_write_b64 v92, v[78:79] offset:16384
    s_bfm_b64 exec, s75, 0
    ds_write_b64 v93, v[80:81] offset:16384
    s_mov_b64 exec, -1
    v_and_b32 v94, 15, v0
    v_lshlrev_b32 v94, 4, v94
    s_lshl_b32 s32, s17, 8
    s_add_u32 s32, s32, 13824
    v_lshrrev_b32 v9, 4, v0
    v_lshl_add_u32 v96, v9, 3, s32
    v_lshrrev_b32 v95, 3, v0
    v_lshlrev_b32 v95, 5, v95
    v_and_b32 v9, 3, v0
    v_lshl_add_u32 v95, v9, 3, v95
    v_bfe_u32 v9, v0, 2, 1
    v_lshl_add_u32 v95, v9, 2, v95
    v_add_u32 v95, s32, v95
    s_waitcnt lgkmcnt(0)
    s_barrier
    v_lshlrev_b32 v88, 4, v0
    v_mov_b32 v86, 4096
    s_lshl_b32 s32, s17, 7
    v_lshl_add_u32 v90, v0, 2, s32
    ds_read_b128 v[82:85], v88 offset:0
    ds_read_b32 v86, v86
    ds_read_b32 v90, v90 offset:0
    v_lshrrev_b32 v87, 3, v0
    v_mul_u32_u24 v87, 20, v87
    v_and_b32 v89, 7, v0
    v_lshlrev_b32 v89, 2, v89
    v_min_u32 v89, 20, v89
    v_add_u32 v89, v89, v87
    v_mul_u32_u24 v89, 114, v89
    v_and_b32 v87, 7, v0
    v_cmp_gt_u32 vcc, 5, v87
    v_mov_b32 v87, 114
    s_waitcnt lgkmcnt(0)
    v_cndmask_b32 v87, 0, v87, vcc
    v_readfirstlane_b32 s21, v86
    v_sub_u32 v82, v82, v89
    v_add_u32 v89, v89, v87
    v_sub_u32 v83, v83, v89
    v_add_u32 v89, v89, v87
    v_sub_u32 v84, v84, v89
    v_add_u32 v89, v89, v87
    v_sub_u32 v85, v85, v89
    v_max_u32 v86, v82, v83
    v_max3_u32 v86, v86, v84, v85
    v_cmp_lt_u32 vcc, 114, v86
    s_cmp_lg_u32 s21, 0
    s_cbranch_scc1 K3_clear
K3_keep:
    s_cbranch_vccnz K3_over
    s_mul_i32 s32, s17, 2280
    v_min_u32 v89, 20, v0
    v_mul_u32_u24 v89, 114, v89
    v_add_u32 v89, s32, v89
    v_cmp_gt_u32 vcc, 20, v0
    v_sub_u32 v82, v90, v89
    s_nop 0
    v_cndmask_b32 v86, 0, v82, vcc
    s_nop 1
    v_add_u32_dpp v86, v86, v86 row_shr:1 row_mask:0xf bank_mask:0xf bound_ctrl:0
    s_nop 1
    v_add_u32_dpp v86, v86, v86 row_shr:2 row_mask:0xf bank_mask:0xf bound_ctrl:0
    s_nop 1
    v_add_u32_dpp v86, v86, v86 row_shr:4 row_mask:0xf bank_mask:0xf bound_ctrl:0
    s_nop 1
    v_add_u32_dpp v86, v86, v86 row_shr:8 row_mask:0xf bank_mask:0xf bound_ctrl:0
    s_nop 1
    v_add_u32_dpp v86, v86, v86 row_bcast:15 row_mask:0xa bank_mask:0xf
    s_nop 1
    v_add_u32_dpp v86, v86, v86 row_bcast:31 row_mask:0xc bank_mask:0xf
    v_sub_u32 v87, v90, v86
    v_lshl_or_b32 v87, v87, 16, v86
    v_readlane_b32 s22, v86, 19
    v_readlane_b32 s40, v87, 0
    v_readlane_b32 s41, v87, 1
    v_readlane_b32 s42, v87, 2
    v_readlane_b32 s43, v87, 3
    v_readlane_b32 s44, v87, 4
    v_readlane_b32 s45, v87, 5
    v_readlane_b32 s46, v87, 6
    v_readlane_b32 s47, v87, 7
    v_readlane_b32 s48, v87, 8
    v_readlane_b32 s49, v87, 9
    v_readlane_b32 s50, v87, 10
    v_readlane_b32 s51, v87, 11
    v_readlane_b32 s52, v87, 12
    v_readlane_b32 s53, v87, 13
    v_readlane_b32 s54, v87, 14
    v_readlane_b32 s55, v87, 15
    v_readlane_b32 s56, v87, 16
    v_readlane_b32 s57, v87, 17
    v_readlane_b32 s58, v87, 18
    v_readlane_b32 s59, v87, 19
    s_or_b32 s59, s59, 0xffff
K3_placed:
    s_cmp_eq_u32 s22, 0
    s_cbranch_scc1 K3_swept
    s_mov_b32 s39, 0
    s_mov_b32 s70, 0
    s_and_b32 s71, s40, 0xffff
    s_lshr_b32 s72, s40, 16
    s_lshl_b32 s72, s72, 3
    s_lshl_b32 s32, s17, 2
    s_add_u32 s35, s32, 4112
    s_xor_b32 s32, s32, 16
    s_add_u32 s31, s32, 4112
    v_add_u32 v88, s72, v7
    s_add_u32 s33, s70, 64
    s_cmp_ge_u32 s71, s33
    s_cbranch_scc1 K3_same0
K3_cross0:
    s_add_u32 s39, s39, 1
    s_mov_b32 m0, s39
    s_sub_u32 s32, s71, s70
    s_movrels_b32 s71, s40
    v_cmp_le_u32 vcc, s32, v0
    s_lshr_b32 s72, s71, 16
    s_lshl_b32 s72, s72, 3
    s_and_b32 s71, s71, 0xffff
    v_add_u32 v97, s72, v7
    v_cndmask_b32 v88, v88, v97, vcc
    s_cmp_lt_u32 s71, s33
    s_cbranch_scc1 K3_cross0
K3_same0:
    ds_read_b64 v[82:83], v88 offset:16384
    v_add_u32 v7, 512, v7
    s_mov_b32 s70, s33
    s_waitcnt lgkmcnt(0)
    v_cmp_gt_i32 vcc, s22, v0
    v_mov_b32 v86, s29
    v_mov_b32 v87, 1.0
    v_cndmask_b32 v82, v86, v82, vcc
    v_cndmask_b32 v83, v87, v83, vcc
    v_and_b32 v97, s29, v82
    ds_write_b32 v95, v97
    ds_read_b64 v[78:79], v96 offset:0
    ds_read_b64 v[80:81], v96 offset:32
    s_waitcnt lgkmcnt(0)
    v_add_u32 v78, v78, v94
    buffer_load_dwordx4 v[10:13], v78, s[4:7], 0 offen
    v_add_u32 v79, v79, v94
    buffer_load_dwordx4 v[14:17], v79, s[4:7], 0 offen
    v_add_u32 v80, v80, v94
    buffer_load_dwordx4 v[18:21], v80, s[4:7], 0 offen
    v_add_u32 v81, v81, v94
    buffer_load_dwordx4 v[22:25], v81, s[4:7], 0 offen
    ds_read_b64 v[78:79], v96 offset:64
    ds_read_b64 v[80:81], v96 offset:96
    s_waitcnt lgkmcnt(0)
    v_add_u32 v78, v78, v94
    buffer_load_dwordx4 v[26:29], v78, s[4:7], 0 offen
    v_add_u32 v79, v79, v94
    buffer_load_dwordx4 v[30:33], v79, s[4:7], 0 offen
    v_add_u32 v80, v80, v94
    buffer_load_dwordx4 v[34:37], v80, s[4:7], 0 offen
    ds_read_b64 v[78:79], v96 offset:128
    v_mov_b32 v93, 0xffff0000
    s_lshl_b32 s32, s17, 10
    s_add_u32 s32, s32, 5632
    v_lshl_add_u32 v9, v0, 4, s32
    v_bfe_u32 v86, v0, 3, 2
    v_bfe_u32 v87, v0, 1, 1
    v_lshl_add_u32 v86, v86, 1, v87
    v_and_b32 v87, 1, v0
    v_lshlrev_b32 v86, 4, v86
    v_lshlrev_b32 v88, 3, v87
    v_sub_u32 v86, v86, v88
    v_add_u32 v86, s32, v86
    v_bfe_u32 v88, v0, 2, 1
    v_lshrrev_b32 v89, 5, v0
    v_cmp_eq_u32 vcc, v88, v89
    v_mov_b32 v88, 4352
    v_lshrrev_b32 v89, 4, v0
    v_cndmask_b32 v8, v88, v86, vcc
    v_mov_b32 v86, 0x3f80
    v_cmp_eq_u32 vcc, 1, v87
    v_bfe_u32 v88, v0, 1, 1
    v_bfe_u32 v84, v0, 2, 2
    v_cndmask_b32 v86, v86, 1.0, vcc
    v_sub_u32 v89, v89, v88
    v_lshl_add_u32 v89, v89, 2, v84
    s_cmp_eq_u32 s74, 0
    s_cbranch_scc1 K3_unpacked
    s_and_b32 s26, s24, 0xffff0000
    s_lshl_b32 s24, s24, 16
    s_lshl_b32 s32, s25, 16
    s_mov_b32 s25, s26
    s_mov_b32 s26, s32
    s_lshl_b32 s34, s34, 16
    s_mov_b32 s32, 0x05040100
    s_mov_b32 s33, 0x07060302
    v_perm_b32 v87, v4, v2, s32
    v_perm_b32 v88, v5, v3, s32
    v_perm_b32 v4, v4, v2, s33
    v_perm_b32 v5, v5, v3, s33
    v_mov_b32 v2, v87
    v_mov_b32 v3, v88
K3_unpacked:
    v_cmp_eq_u32 s[36:37], 0, v89
    v_cmp_eq_u32 s[32:33], 1, v89
    s_nop 0
    v_cndmask_b32 v70, 0, v86, s[36:37]
    v_cndmask_b32 v71, 0, v86, s[32:33]
    v_cmp_eq_u32 s[36:37], 2, v89
    v_cmp_eq_u32 s[32:33], 3, v89
    s_nop 0
    v_cndmask_b32 v72, 0, v86, s[36:37]
    v_cndmask_b32 v73, 0, v86, s[32:33]
    v_cmp_eq_u32 s[36:37], 8, v89
    v_cmp_eq_u32 s[32:33], 9, v89
    s_nop 0
    v_cndmask_b32 v74, 0, v86, s[36:37]
    v_cndmask_b32 v75, 0, v86, s[32:33]
    v_cmp_eq_u32 s[36:37], 10, v89
    v_cmp_eq_u32 s[32:33], 11, v89
    s_nop 0
    v_cndmask_b32 v76, 0, v86, s[36:37]
    v_cndmask_b32 v77, 0, v86, s[32:33]
    v_and_b32 v86, v93, v83
    v_lshlrev_b32 v83, 16, v83
    v_rcp_f32 v92, v86
    v_mul_f32 v86, s34, v86
    v_cvt_pk_bf16_f32 v86, v86, v86
    v_and_b32 v86, v93, v86
    v_mul_f32 v87, s27, v86
    v_rndne_f32 v88, v87
    v_sub_f32 v87, v87, v88
    v_fma_f32 v86, v86, s28, v87
    v_sin_f32 v86, v86
    v_or_b32_sdwa v91, v82, s30 dst_sel:DWORD dst_unused:UNUSED_PAD src0_sel:BYTE_0 src1_sel:DWORD
    v_cvt_pk_bf16_f32 v86, v86, v86
    v_and_b32 v86, v93, v86
    v_mul_f32 v92, v86, v92
    v_cvt_pk_bf16_f32 v92, v92, v92
    v_and_b32 v92, v93, v92
    v_mul_f32 v86, s24, v83
    v_mul_f32 v87, s25, v83
    v_mov_b32_dpp v89, v91 quad_perm:[1,1,3,3] row_mask:0xf bank_mask:0xf
    v_mul_f32 v88, s26, v83
    v_lshl_or_b32 v91, v89, 16, v91
    v_cvt_pk_bf16_f32 v86, v86, v87
    v_cvt_pk_bf16_f32 v88, v88, v88
    v_and_b32 v87, v93, v86
    v_lshlrev_b32 v86, 16, v86
    v_and_b32 v88, v93, v88
    v_mul_f32 v84, s27, v86
    v_mul_f32 v85, s27, v87
    v_mul_f32 v89, s27, v88
    v_fract_f32 v84, v84
    v_fract_f32 v85, v85
    v_fract_f32 v89, v89
    v_fma_f32 v86, v86, s28, v84
    v_fma_f32 v87, v87, s28, v85
    v_fma_f32 v88, v88, s28, v89
    v_cos_f32 v86, v86
    v_cos_f32 v87, v87
    v_cos_f32 v88, v88
    v_cmp_gt_i32 vcc, 0, v82
    v_cvt_pk_bf16_f32 v86, v86, v87
    v_cvt_pk_bf16_f32 v88, v88, v88
    v_and_b32 v87, v93, v86
    v_lshlrev_b32 v86, 16, v86
    v_and_b32 v88, v93, v88
    v_mul_f32 v86, v86, v92
    v_mul_f32 v87, v87, v92
    v_mul_f32 v88, v88, v92
    v_cvt_pk_bf16_f32 v84, v86, v87
    v_cvt_pk_bf16_f32 v85, v88, 0
    v_cndmask_b32 v84, v84, 0, vcc
    v_cndmask_b32 v85, v85, v92, vcc
    ds_write_b64 v9, v[84:85]
    v_mov_b32 v90, v91
    ds_read2_b64 v[66:69], v8 offset0:0 offset1:1
K3_batch:
    s_waitcnt lgkmcnt(0)
    v_mfma_f32_32x32x16_bf16 v[42:57], v[66:69], v[2:5], 0
    s_sub_u32 s22, s22, 64
    v_add_u32 v88, s72, v7
    s_add_u32 s33, s70, 64
    s_cmp_ge_u32 s71, s33
    s_cbranch_scc1 K3_same1
K3_cross1:
    s_add_u32 s39, s39, 1
    s_mov_b32 m0, s39
    s_sub_u32 s32, s71, s70
    s_movrels_b32 s71, s40
    v_cmp_le_u32 vcc, s32, v0
    s_lshr_b32 s72, s71, 16
    s_lshl_b32 s72, s72, 3
    s_and_b32 s71, s71, 0xffff
    v_add_u32 v97, s72, v7
    v_cndmask_b32 v88, v88, v97, vcc
    s_cmp_lt_u32 s71, s33
    s_cbranch_scc1 K3_cross1
K3_same1:
    ds_read_b64 v[82:83], v88 offset:16384
    v_add_u32 v7, 512, v7
    s_mov_b32 s70, s33
    v_mov_b32 v86, s35
    v_mov_b32 v87, s22
    v_mov_b32 v89, s31
    ds_write_b32 v86, v87
    ds_read_b32 v89, v89
    ds_read2_b64 v[66:69], v8 offset0:16 offset1:17
    s_waitcnt vmcnt(6)
    v_mfma_f32_16x16x32_bf16 v[58:61], v[70:73], v[10:13], 0
    v_mfma_f32_16x16x32_bf16 v[62:65], v[74:77], v[10:13], 0
    v_add_u32 v81, v81, v94
    buffer_load_dwordx4 v[38:41], v81, s[4:7], 0 offen
    ds_read_b64 v[80:81], v96 offset:160
    v_readlane_b32 s36, v90, 0
    v_readlane_b32 s37, v90, 2
    s_set_gpr_idx_on s36, gpr_idx(SRC2,DST)
    s_nop 0
    v_pk_fma_f32 v[98:99], v[58:59], v[42:43], v[98:99]
    s_lshr_b32 m0, s36, 16
    v_pk_fma_f32 v[98:99], v[60:61], v[44:45], v[98:99]
    s_mov_b32 m0, s37
    v_pk_fma_f32 v[98:99], v[62:63], v[46:47], v[98:99]
    s_lshr_b32 m0, s37, 16
    v_pk_fma_f32 v[98:99], v[64:65], v[48:49], v[98:99]
    s_set_gpr_idx_off
    s_waitcnt vmcnt(6)
    v_mfma_f32_16x16x32_bf16 v[58:61], v[70:73], v[14:17], 0
    v_mfma_f32_16x16x32_bf16 v[62:65], v[74:77], v[14:17], 0
    v_add_u32 v78, v78, v94
    buffer_load_dwordx4 v[10:13], v78, s[4:7], 0 offen
    v_readlane_b32 s36, v90, 4
    v_readlane_b32 s37, v90, 6
    s_set_gpr_idx_on s36, gpr_idx(SRC2,DST)
    s_nop 1
    v_pk_fma_f32 v[98:99], v[58:59], v[50:51], v[98:99]
    s_lshr_b32 m0, s36, 16
    v_pk_fma_f32 v[98:99], v[60:61], v[52:53], v[98:99]
    s_mov_b32 m0, s37
    v_pk_fma_f32 v[98:99], v[62:63], v[54:55], v[98:99]
    s_lshr_b32 m0, s37, 16
    v_pk_fma_f32 v[98:99], v[64:65], v[56:57], v[98:99]
    s_set_gpr_idx_off
    s_waitcnt lgkmcnt(0)
    v_mfma_f32_32x32x16_bf16 v[42:57], v[66:69], v[2:5], 0
    v_readfirstlane_b32 s32, v89
    s_cmp_gt_i32 s22, s32
    s_cbranch_scc1 K3_behind
    s_setprio 0
    s_branch K3_prio
K3_behind:
    s_setprio 1
K3_prio:
    ds_read2_b64 v[66:69], v8 offset0:32 offset1:33
    s_waitcnt vmcnt(6)
    v_mfma_f32_16x16x32_bf16 v[58:61], v[70:73], v[18:21], 0
    v_mfma_f32_16x16x32_bf16 v[62:65], v[74:77], v[18:21], 0
    v_add_u32 v79, v79, v94
    buffer_load_dwordx4 v[14:17], v79, s[4:7], 0 offen
    ds_read_b64 v[78:79], v96 offset:192
    v_readlane_b32 s36, v90, 8
    v_readlane_b32 s37, v90, 10
    v_cmp_gt_i32 vcc, s22, v0
    v_mov_b32 v86, s29
    v_mov_b32 v87, 1.0
    v_cndmask_b32 v82, v86, v82, vcc
    v_cndmask_b32 v83, v87, v83, vcc
    s_set_gpr_idx_on s36, gpr_idx(SRC2,DST)
    v_pk_fma_f32 v[98:99], v[58:59], v[42:43], v[98:99]
    s_lshr_b32 m0, s36, 16
    v_pk_fma_f32 v[98:99], v[60:61], v[44:45], v[98:99]
    s_mov_b32 m0, s37
    v_pk_fma_f32 v[98:99], v[62:63], v[46:47], v[98:99]
    s_lshr_b32 m0, s37, 16
    v_pk_fma_f32 v[98:99], v[64:65], v[48:49], v[98:99]
    s_set_gpr_idx_off
    s_waitcnt vmcnt(6)
    v_mfma_f32_16x16x32_bf16 v[58:61], v[70:73], v[22:25], 0
    v_mfma_f32_16x16x32_bf16 v[62:65], v[74:77], v[22:25], 0
    v_add_u32 v80, v80, v94
    buffer_load_dwordx4 v[18:21], v80, s[4:7], 0 offen
    v_readlane_b32 s36, v90, 12
    v_readlane_b32 s37, v90, 14
    v_and_b32 v86, v93, v83
    v_lshlrev_b32 v83, 16, v83
    v_rcp_f32 v92, v86
    v_mul_f32 v86, s34, v86
    v_cvt_pk_bf16_f32 v86, v86, v86
    s_set_gpr_idx_on s36, gpr_idx(SRC2,DST)
    v_pk_fma_f32 v[98:99], v[58:59], v[50:51], v[98:99]
    s_lshr_b32 m0, s36, 16
    v_pk_fma_f32 v[98:99], v[60:61], v[52:53], v[98:99]
    s_mov_b32 m0, s37
    v_pk_fma_f32 v[98:99], v[62:63], v[54:55], v[98:99]
    s_lshr_b32 m0, s37, 16
    v_pk_fma_f32 v[98:99], v[64:65], v[56:57], v[98:99]
    s_set_gpr_idx_off
    s_cmp_le_i32 s22, -48
    s_cbranch_scc1 K3_drain
    s_waitcnt lgkmcnt(0)
    v_mfma_f32_32x32x16_bf16 v[42:57], v[66:69], v[2:5], 0
    ds_read2_b64 v[66:69], v8 offset0:48 offset1:49
    s_waitcnt vmcnt(6)
    v_mfma_f32_16x16x32_bf16 v[58:61], v[70:73], v[26:29], 0
    v_mfma_f32_16x16x32_bf16 v[62:65], v[74:77], v[26:29], 0
    v_add_u32 v81, v81, v94
    buffer_load_dwordx4 v[22:25], v81, s[4:7], 0 offen
    ds_read_b64 v[80:81], v96 offset:224
    v_readlane_b32 s36, v90, 16
    v_readlane_b32 s37, v90, 18
    v_and_b32 v86, v93, v86
    v_mul_f32 v87, s27, v86
    v_rndne_f32 v88, v87
    v_sub_f32 v87, v87, v88
    v_fma_f32 v86, v86, s28, v87
    s_set_gpr_idx_on s36, gpr_idx(SRC2,DST)
    v_pk_fma_f32 v[98:99], v[58:59], v[42:43], v[98:99]
    s_lshr_b32 m0, s36, 16
    v_pk_fma_f32 v[98:99], v[60:61], v[44:45], v[98:99]
    s_mov_b32 m0, s37
    v_pk_fma_f32 v[98:99], v[62:63], v[46:47], v[98:99]
    s_lshr_b32 m0, s37, 16
    v_pk_fma_f32 v[98:99], v[64:65], v[48:49], v[98:99]
    s_set_gpr_idx_off
    s_waitcnt vmcnt(6)
    v_mfma_f32_16x16x32_bf16 v[58:61], v[70:73], v[30:33], 0
    v_mfma_f32_16x16x32_bf16 v[62:65], v[74:77], v[30:33], 0
    v_add_u32 v78, v78, v94
    buffer_load_dwordx4 v[26:29], v78, s[4:7], 0 offen
    v_readlane_b32 s36, v90, 20
    v_readlane_b32 s37, v90, 22
    v_sin_f32 v86, v86
    v_or_b32_sdwa v91, v82, s30 dst_sel:DWORD dst_unused:UNUSED_PAD src0_sel:BYTE_0 src1_sel:DWORD
    v_cvt_pk_bf16_f32 v86, v86, v86
    v_and_b32 v86, v93, v86
    v_mul_f32 v92, v86, v92
    s_set_gpr_idx_on s36, gpr_idx(SRC2,DST)
    v_pk_fma_f32 v[98:99], v[58:59], v[50:51], v[98:99]
    s_lshr_b32 m0, s36, 16
    v_pk_fma_f32 v[98:99], v[60:61], v[52:53], v[98:99]
    s_mov_b32 m0, s37
    v_pk_fma_f32 v[98:99], v[62:63], v[54:55], v[98:99]
    s_lshr_b32 m0, s37, 16
    v_pk_fma_f32 v[98:99], v[64:65], v[56:57], v[98:99]
    s_set_gpr_idx_off
    s_waitcnt lgkmcnt(0)
    v_mfma_f32_32x32x16_bf16 v[42:57], v[66:69], v[2:5], 0
    ds_read2_b64 v[66:69], v8 offset0:64 offset1:65
    s_waitcnt vmcnt(6)
    v_mfma_f32_16x16x32_bf16 v[58:61], v[70:73], v[34:37], 0
    v_mfma_f32_16x16x32_bf16 v[62:65], v[74:77], v[34:37], 0
    v_add_u32 v79, v79, v94
    buffer_load_dwordx4 v[30:33], v79, s[4:7], 0 offen
    v_and_b32 v97, s29, v82
    ds_write_b32 v95, v97
    ds_read_b64 v[78:79], v96 offset:0
    v_readlane_b32 s36, v90, 24
    v_readlane_b32 s37, v90, 26
    v_cvt_pk_bf16_f32 v92, v92, v92
    v_and_b32 v92, v93, v92
    v_mul_f32 v86, s24, v83
    v_mul_f32 v87, s25, v83
    s_set_gpr_idx_on s36, gpr_idx(SRC2,DST)
    v_pk_fma_f32 v[98:99], v[58:59], v[42:43], v[98:99]
    s_lshr_b32 m0, s36, 16
    v_pk_fma_f32 v[98:99], v[60:61], v[44:45], v[98:99]
    s_mov_b32 m0, s37
    v_pk_fma_f32 v[98:99], v[62:63], v[46:47], v[98:99]
    s_lshr_b32 m0, s37, 16
    v_pk_fma_f32 v[98:99], v[64:65], v[48:49], v[98:99]
    s_set_gpr_idx_off
    s_waitcnt vmcnt(6)
    v_mfma_f32_16x16x32_bf16 v[58:61], v[70:73], v[38:41], 0
    v_mfma_f32_16x16x32_bf16 v[62:65], v[74:77], v[38:41], 0
    v_add_u32 v80, v80, v94
    buffer_load_dwordx4 v[34:37], v80, s[4:7], 0 offen
    v_readlane_b32 s36, v90, 28
    v_readlane_b32 s37, v90, 30
    v_mov_b32_dpp v89, v91 quad_perm:[1,1,3,3] row_mask:0xf bank_mask:0xf
    v_mul_f32 v88, s26, v83
    v_lshl_or_b32 v91, v89, 16, v91
    v_cvt_pk_bf16_f32 v86, v86, v87
    v_cvt_pk_bf16_f32 v88, v88, v88
    s_set_gpr_idx_on s36, gpr_idx(SRC2,DST)
    v_pk_fma_f32 v[98:99], v[58:59], v[50:51], v[98:99]
    s_lshr_b32 m0, s36, 16
    v_pk_fma_f32 v[98:99], v[60:61], v[52:53], v[98:99]
    s_mov_b32 m0, s37
    v_pk_fma_f32 v[98:99], v[62:63], v[54:55], v[98:99]
    s_lshr_b32 m0, s37, 16
    v_pk_fma_f32 v[98:99], v[64:65], v[56:57], v[98:99]
    s_set_gpr_idx_off
    s_cmp_le_i32 s22, -32
    s_cbranch_scc1 K3_drain
    s_waitcnt lgkmcnt(0)
    v_mfma_f32_32x32x16_bf16 v[42:57], v[66:69], v[2:5], 0
    ds_read2_b64 v[66:69], v8 offset0:80 offset1:81
    s_waitcnt vmcnt(6)
    v_mfma_f32_16x16x32_bf16 v[58:61], v[70:73], v[10:13], 0
    v_mfma_f32_16x16x32_bf16 v[62:65], v[74:77], v[10:13], 0
    v_add_u32 v81, v81, v94
    buffer_load_dwordx4 v[38:41], v81, s[4:7], 0 offen
    ds_read_b64 v[80:81], v96 offset:32
    v_readlane_b32 s36, v90, 32
    v_readlane_b32 s37, v90, 34
    v_and_b32 v87, v93, v86
    v_lshlrev_b32 v86, 16, v86
    v_and_b32 v88, v93, v88
    v_mul_f32 v84, s27, v86
    v_mul_f32 v85, s27, v87
    s_set_gpr_idx_on s36, gpr_idx(SRC2,DST)
    v_pk_fma_f32 v[98:99], v[58:59], v[42:43], v[98:99]
    s_lshr_b32 m0, s36, 16
    v_pk_fma_f32 v[98:99], v[60:61], v[44:45], v[98:99]
    s_mov_b32 m0, s37
    v_pk_fma_f32 v[98:99], v[62:63], v[46:47], v[98:99]
    s_lshr_b32 m0, s37, 16
    v_pk_fma_f32 v[98:99], v[64:65], v[48:49], v[98:99]
    s_set_gpr_idx_off
    s_waitcnt vmcnt(6)
    v_mfma_f32_16x16x32_bf16 v[58:61], v[70:73], v[14:17], 0
    v_mfma_f32_16x16x32_bf16 v[62:65], v[74:77], v[14:17], 0
    v_add_u32 v78, v78, v94
    buffer_load_dwordx4 v[10:13], v78, s[4:7], 0 offen
    v_readlane_b32 s36, v90, 36
    v_readlane_b32 s37, v90, 38
    v_mul_f32 v89, s27, v88
    v_fract_f32 v84, v84
    v_fract_f32 v85, v85
    v_fract_f32 v89, v89
    v_fma_f32 v86, v86, s28, v84
    s_set_gpr_idx_on s36, gpr_idx(SRC2,DST)
    v_pk_fma_f32 v[98:99], v[58:59], v[50:51], v[98:99]
    s_lshr_b32 m0, s36, 16
    v_pk_fma_f32 v[98:99], v[60:61], v[52:53], v[98:99]
    s_mov_b32 m0, s37
    v_pk_fma_f32 v[98:99], v[62:63], v[54:55], v[98:99]
    s_lshr_b32 m0, s37, 16
    v_pk_fma_f32 v[98:99], v[64:65], v[56:57], v[98:99]
    s_set_gpr_idx_off
    s_waitcnt lgkmcnt(0)
    v_mfma_f32_32x32x16_bf16 v[42:57], v[66:69], v[2:5], 0
    ds_read2_b64 v[66:69], v8 offset0:96 offset1:97
    s_waitcnt vmcnt(6)
    v_mfma_f32_16x16x32_bf16 v[58:61], v[70:73], v[18:21], 0
    v_mfma_f32_16x16x32_bf16 v[62:65], v[74:77], v[18:21], 0
    v_add_u32 v79, v79, v94
    buffer_load_dwordx4 v[14:17], v79, s[4:7], 0 offen
    ds_read_b64 v[78:79], v96 offset:64
    v_readlane_b32 s36, v90, 40
    v_readlane_b32 s37, v90, 42
    v_fma_f32 v87, v87, s28, v85
    v_fma_f32 v88, v88, s28, v89
    v_cos_f32 v86, v86
    v_cos_f32 v87, v87
    s_set_gpr_idx_on s36, gpr_idx(SRC2,DST)
    v_pk_fma_f32 v[98:99], v[58:59], v[42:43], v[98:99]
    s_lshr_b32 m0, s36, 16
    v_pk_fma_f32 v[98:99], v[60:61], v[44:45], v[98:99]
    s_mov_b32 m0, s37
    v_pk_fma_f32 v[98:99], v[62:63], v[46:47], v[98:99]
    s_lshr_b32 m0, s37, 16
    v_pk_fma_f32 v[98:99], v[64:65], v[48:49], v[98:99]
    s_set_gpr_idx_off
    s_waitcnt vmcnt(6)
    v_mfma_f32_16x16x32_bf16 v[58:61], v[70:73], v[22:25], 0
    v_mfma_f32_16x16x32_bf16 v[62:65], v[74:77], v[22:25], 0
    v_add_u32 v80, v80, v94
    buffer_load_dwordx4 v[18:21], v80, s[4:7], 0 offen
    v_readlane_b32 s36, v90, 44
    v_readlane_b32 s37, v90, 46
    v_cos_f32 v88, v88
    v_cmp_gt_i32 vcc, 0, v82
    v_cvt_pk_bf16_f32 v86, v86, v87
    v_cvt_pk_bf16_f32 v88, v88, v88
    v_and_b32 v87, v93, v86
    s_set_gpr_idx_on s36, gpr_idx(SRC2,DST)
    v_pk_fma_f32 v[98:99], v[58:59], v[50:51], v[98:99]
    s_lshr_b32 m0, s36, 16
    v_pk_fma_f32 v[98:99], v[60:61], v[52:53], v[98:99]
    s_mov_b32 m0, s37
    v_pk_fma_f32 v[98:99], v[62:63], v[54:55], v[98:99]
    s_lshr_b32 m0, s37, 16
    v_pk_fma_f32 v[98:99], v[64:65], v[56:57], v[98:99]
    s_set_gpr_idx_off
    s_cmp_le_i32 s22, -16
    s_cbranch_scc1 K3_drain
    s_waitcnt lgkmcnt(0)
    v_mfma_f32_32x32x16_bf16 v[42:57], v[66:69], v[2:5], 0
    ds_read2_b64 v[66:69], v8 offset0:112 offset1:113
    s_waitcnt vmcnt(6)
    v_mfma_f32_16x16x32_bf16 v[58:61], v[70:73], v[26:29], 0
    v_mfma_f32_16x16x32_bf16 v[62:65], v[74:77], v[26:29], 0
    v_add_u32 v81, v81, v94
    buffer_load_dwordx4 v[22:25], v81, s[4:7], 0 offen
    ds_read_b64 v[80:81], v96 offset:96
    v_readlane_b32 s36, v90, 48
    v_readlane_b32 s37, v90, 50
    v_lshlrev_b32 v86, 16, v86
    v_and_b32 v88, v93, v88
    v_mul_f32 v86, v86, v92
    v_mul_f32 v87, v87, v92
    v_mul_f32 v88, v88, v92
    s_set_gpr_idx_on s36, gpr_idx(SRC2,DST)
    v_pk_fma_f32 v[98:99], v[58:59], v[42:43], v[98:99]
    s_lshr_b32 m0, s36, 16
    v_pk_fma_f32 v[98:99], v[60:61], v[44:45], v[98:99]
    s_mov_b32 m0, s37
    v_pk_fma_f32 v[98:99], v[62:63], v[46:47], v[98:99]
    s_lshr_b32 m0, s37, 16
    v_pk_fma_f32 v[98:99], v[64:65], v[48:49], v[98:99]
    s_set_gpr_idx_off
    s_waitcnt vmcnt(6)
    v_mfma_f32_16x16x32_bf16 v[58:61], v[70:73], v[30:33], 0
    v_mfma_f32_16x16x32_bf16 v[62:65], v[74:77], v[30:33], 0
    v_add_u32 v78, v78, v94
    buffer_load_dwordx4 v[26:29], v78, s[4:7], 0 offen
    v_readlane_b32 s36, v90, 52
    v_readlane_b32 s37, v90, 54
    v_cvt_pk_bf16_f32 v84, v86, v87
    v_cvt_pk_bf16_f32 v85, v88, 0
    v_cndmask_b32 v84, v84, 0, vcc
    v_cndmask_b32 v85, v85, v92, vcc
    s_set_gpr_idx_on s36, gpr_idx(SRC2,DST)
    v_pk_fma_f32 v[98:99], v[58:59], v[50:51], v[98:99]
    s_lshr_b32 m0, s36, 16
    v_pk_fma_f32 v[98:99], v[60:61], v[52:53], v[98:99]
    s_mov_b32 m0, s37
    v_pk_fma_f32 v[98:99], v[62:63], v[54:55], v[98:99]
    s_lshr_b32 m0, s37, 16
    v_pk_fma_f32 v[98:99], v[64:65], v[56:57], v[98:99]
    s_set_gpr_idx_off
    s_waitcnt lgkmcnt(0)
    v_mfma_f32_32x32x16_bf16 v[42:57], v[66:69], v[2:5], 0
    ds_write_b64 v9, v[84:85]
    ds_read2_b64 v[66:69], v8 offset0:0 offset1:1
    s_waitcnt vmcnt(6)
    v_mfma_f32_16x16x32_bf16 v[58:61], v[70:73], v[34:37], 0
    v_mfma_f32_16x16x32_bf16 v[62:65], v[74:77], v[34:37], 0
    v_add_u32 v79, v79, v94
    buffer_load_dwordx4 v[30:33], v79, s[4:7], 0 offen
    ds_read_b64 v[78:79], v96 offset:128
    v_readlane_b32 s36, v90, 56
    v_readlane_b32 s37, v90, 58
    s_set_gpr_idx_on s36, gpr_idx(SRC2,DST)
    s_nop 0
    v_pk_fma_f32 v[98:99], v[58:59], v[42:43], v[98:99]
    s_lshr_b32 m0, s36, 16
    v_pk_fma_f32 v[98:99], v[60:61], v[44:45], v[98:99]
    s_mov_b32 m0, s37
    v_pk_fma_f32 v[98:99], v[62:63], v[46:47], v[98:99]
    s_lshr_b32 m0, s37, 16
    v_pk_fma_f32 v[98:99], v[64:65], v[48:49], v[98:99]
    s_set_gpr_idx_off
    s_waitcnt vmcnt(6)
    v_mfma_f32_16x16x32_bf16 v[58:61], v[70:73], v[38:41], 0
    v_mfma_f32_16x16x32_bf16 v[62:65], v[74:77], v[38:41], 0
    v_add_u32 v80, v80, v94
    buffer_load_dwordx4 v[34:37], v80, s[4:7], 0 offen
    v_readlane_b32 s36, v90, 60
    v_readlane_b32 s37, v90, 62
    s_set_gpr_idx_on s36, gpr_idx(SRC2,DST)
    s_nop 1
    v_pk_fma_f32 v[98:99], v[58:59], v[50:51], v[98:99]
    s_lshr_b32 m0, s36, 16
    v_pk_fma_f32 v[98:99], v[60:61], v[52:53], v[98:99]
    s_mov_b32 m0, s37
    v_pk_fma_f32 v[98:99], v[62:63], v[54:55], v[98:99]
    s_lshr_b32 m0, s37, 16
    v_pk_fma_f32 v[98:99], v[64:65], v[56:57], v[98:99]
    s_set_gpr_idx_off
    v_mov_b32 v90, v91
    s_cmp_gt_i32 s22, 0
    s_cbranch_scc1 K3_batch
K3_drain:
    s_waitcnt vmcnt(0) lgkmcnt(0)
K3_swept:
    s_mov_b32 s74, 0
    s_mov_b32 s75, 0
    s_waitcnt lgkmcnt(0)
    s_cmp_lg_u32 s21, 0
    s_cbranch_scc1 K3_round
    v_and_b32 v7, 15, v0
    v_lshrrev_b32 v8, 4, v0
    v_lshlrev_b32 v7, 4, v7
    v_lshl_add_u32 v7, v8, 19, v7
    s_lshl_b32 s32, s17, 8
    s_add_u32 s32, s32, s16
    s_lshl_b32 s32, s32, 8
    v_cvt_pk_bf16_f32 v10, v98, v99
    v_cvt_pk_bf16_f32 v11, v100, v101
    v_cvt_pk_bf16_f32 v12, v102, v103
    v_cvt_pk_bf16_f32 v13, v104, v105
    s_nop 0
    v_permlane32_swap_b32 v10, v12
    v_permlane32_swap_b32 v11, v13
    s_nop 1
    v_permlane16_swap_b32 v10, v11
    v_permlane16_swap_b32 v12, v13
    buffer_store_dwordx4 v[10:13], v7, s[8:11], s32 offen sc0 sc1
    s_add_u32 s32, s32, 2097152
    v_cvt_pk_bf16_f32 v14, v106, v107
    v_cvt_pk_bf16_f32 v15, v108, v109
    v_cvt_pk_bf16_f32 v16, v110, v111
    v_cvt_pk_bf16_f32 v17, v112, v113
    s_nop 0
    v_permlane32_swap_b32 v14, v16
    v_permlane32_swap_b32 v15, v17
    s_nop 1
    v_permlane16_swap_b32 v14, v15
    v_permlane16_swap_b32 v16, v17
    buffer_store_dwordx4 v[14:17], v7, s[8:11], s32 offen sc0 sc1
    s_add_u32 s32, s32, 2097152
    v_cvt_pk_bf16_f32 v18, v114, v115
    v_cvt_pk_bf16_f32 v19, v116, v117
    v_cvt_pk_bf16_f32 v20, v118, v119
    v_cvt_pk_bf16_f32 v21, v120, v121
    s_nop 0
    v_permlane32_swap_b32 v18, v20
    v_permlane32_swap_b32 v19, v21
    s_nop 1
    v_permlane16_swap_b32 v18, v19
    v_permlane16_swap_b32 v20, v21
    buffer_store_dwordx4 v[18:21], v7, s[8:11], s32 offen sc0 sc1
    s_add_u32 s32, s32, 2097152
    v_cvt_pk_bf16_f32 v22, v122, v123
    v_cvt_pk_bf16_f32 v23, v124, v125
    v_cvt_pk_bf16_f32 v24, v126, v127
    v_cvt_pk_bf16_f32 v25, v128, v129
    s_nop 0
    v_permlane32_swap_b32 v22, v24
    v_permlane32_swap_b32 v23, v25
    s_nop 1
    v_permlane16_swap_b32 v22, v23
    v_permlane16_swap_b32 v24, v25
    buffer_store_dwordx4 v[22:25], v7, s[8:11], s32 offen sc0 sc1
    s_add_u32 s32, s32, 2097152
    v_cvt_pk_bf16_f32 v26, v130, v131
    v_cvt_pk_bf16_f32 v27, v132, v133
    v_cvt_pk_bf16_f32 v28, v134, v135
    v_cvt_pk_bf16_f32 v29, v136, v137
    s_nop 0
    v_permlane32_swap_b32 v26, v28
    v_permlane32_swap_b32 v27, v29
    s_nop 1
    v_permlane16_swap_b32 v26, v27
    v_permlane16_swap_b32 v28, v29
    buffer_store_dwordx4 v[26:29], v7, s[8:11], s32 offen sc0 sc1
    s_add_u32 s32, s32, 2097152
    v_cvt_pk_bf16_f32 v30, v138, v139
    v_cvt_pk_bf16_f32 v31, v140, v141
    v_cvt_pk_bf16_f32 v32, v142, v143
    v_cvt_pk_bf16_f32 v33, v144, v145
    s_nop 0
    v_permlane32_swap_b32 v30, v32
    v_permlane32_swap_b32 v31, v33
    s_nop 1
    v_permlane16_swap_b32 v30, v31
    v_permlane16_swap_b32 v32, v33
    buffer_store_dwordx4 v[30:33], v7, s[8:11], s32 offen sc0 sc1
    s_add_u32 s32, s32, 2097152
    v_cvt_pk_bf16_f32 v34, v146, v147
    v_cvt_pk_bf16_f32 v35, v148, v149
    v_cvt_pk_bf16_f32 v36, v150, v151
    v_cvt_pk_bf16_f32 v37, v152, v153
    s_nop 0
    v_permlane32_swap_b32 v34, v36
    v_permlane32_swap_b32 v35, v37
    s_nop 1
    v_permlane16_swap_b32 v34, v35
    v_permlane16_swap_b32 v36, v37
    buffer_store_dwordx4 v[34:37], v7, s[8:11], s32 offen sc0 sc1
    s_add_u32 s32, s32, 2097152
    v_cvt_pk_bf16_f32 v38, v154, v155
    v_cvt_pk_bf16_f32 v39, v156, v157
    v_cvt_pk_bf16_f32 v40, v158, v159
    v_cvt_pk_bf16_f32 v41, v160, v161
    s_nop 0
    v_permlane32_swap_b32 v38, v40
    v_permlane32_swap_b32 v39, v41
    s_nop 1
    v_permlane16_swap_b32 v38, v39
    v_permlane16_swap_b32 v40, v41
    buffer_store_dwordx4 v[38:41], v7, s[8:11], s32 offen sc0 sc1
    s_add_u32 s32, s32, 2097152
    v_cvt_pk_bf16_f32 v10, v162, v163
    v_cvt_pk_bf16_f32 v11, v164, v165
    v_cvt_pk_bf16_f32 v12, v166, v167
    v_cvt_pk_bf16_f32 v13, v168, v169
    s_nop 0
    v_permlane32_swap_b32 v10, v12
    v_permlane32_swap_b32 v11, v13
    s_nop 1
    v_permlane16_swap_b32 v10, v11
    v_permlane16_swap_b32 v12, v13
    buffer_store_dwordx4 v[10:13], v7, s[8:11], s32 offen sc0 sc1
    s_add_u32 s32, s32, 2097152
    v_cvt_pk_bf16_f32 v14, v170, v171
    v_cvt_pk_bf16_f32 v15, v172, v173
    v_cvt_pk_bf16_f32 v16, v174, v175
    v_cvt_pk_bf16_f32 v17, v176, v177
    s_nop 0
    v_permlane32_swap_b32 v14, v16
    v_permlane32_swap_b32 v15, v17
    s_nop 1
    v_permlane16_swap_b32 v14, v15
    v_permlane16_swap_b32 v16, v17
    buffer_store_dwordx4 v[14:17], v7, s[8:11], s32 offen sc0 sc1
    s_add_u32 s32, s32, 2097152
    v_cvt_pk_bf16_f32 v18, v178, v179
    v_cvt_pk_bf16_f32 v19, v180, v181
    v_cvt_pk_bf16_f32 v20, v182, v183
    v_cvt_pk_bf16_f32 v21, v184, v185
    s_nop 0
    v_permlane32_swap_b32 v18, v20
    v_permlane32_swap_b32 v19, v21
    s_nop 1
    v_permlane16_swap_b32 v18, v19
    v_permlane16_swap_b32 v20, v21
    buffer_store_dwordx4 v[18:21], v7, s[8:11], s32 offen sc0 sc1
    s_add_u32 s32, s32, 2097152
    v_cvt_pk_bf16_f32 v22, v186, v187
    v_cvt_pk_bf16_f32 v23, v188, v189
    v_cvt_pk_bf16_f32 v24, v190, v191
    v_cvt_pk_bf16_f32 v25, v192, v193
    s_nop 0
    v_permlane32_swap_b32 v22, v24
    v_permlane32_swap_b32 v23, v25
    s_nop 1
    v_permlane16_swap_b32 v22, v23
    v_permlane16_swap_b32 v24, v25
    buffer_store_dwordx4 v[22:25], v7, s[8:11], s32 offen sc0 sc1
    s_add_u32 s32, s32, 2097152
    v_cvt_pk_bf16_f32 v26, v194, v195
    v_cvt_pk_bf16_f32 v27, v196, v197
    v_cvt_pk_bf16_f32 v28, v198, v199
    v_cvt_pk_bf16_f32 v29, v200, v201
    s_nop 0
    v_permlane32_swap_b32 v26, v28
    v_permlane32_swap_b32 v27, v29
    s_nop 1
    v_permlane16_swap_b32 v26, v27
    v_permlane16_swap_b32 v28, v29
    buffer_store_dwordx4 v[26:29], v7, s[8:11], s32 offen sc0 sc1
    s_add_u32 s32, s32, 2097152
    v_cvt_pk_bf16_f32 v30, v202, v203
    v_cvt_pk_bf16_f32 v31, v204, v205
    v_cvt_pk_bf16_f32 v32, v206, v207
    v_cvt_pk_bf16_f32 v33, v208, v209
    s_nop 0
    v_permlane32_swap_b32 v30, v32
    v_permlane32_swap_b32 v31, v33
    s_nop 1
    v_permlane16_swap_b32 v30, v31
    v_permlane16_swap_b32 v32, v33
    buffer_store_dwordx4 v[30:33], v7, s[8:11], s32 offen sc0 sc1
    s_add_u32 s32, s32, 2097152
    v_cvt_pk_bf16_f32 v34, v210, v211
    v_cvt_pk_bf16_f32 v35, v212, v213
    v_cvt_pk_bf16_f32 v36, v214, v215
    v_cvt_pk_bf16_f32 v37, v216, v217
    s_nop 0
    v_permlane32_swap_b32 v34, v36
    v_permlane32_swap_b32 v35, v37
    s_nop 1
    v_permlane16_swap_b32 v34, v35
    v_permlane16_swap_b32 v36, v37
    buffer_store_dwordx4 v[34:37], v7, s[8:11], s32 offen sc0 sc1
    s_add_u32 s32, s32, 2097152
    v_cvt_pk_bf16_f32 v38, v218, v219
    v_cvt_pk_bf16_f32 v39, v220, v221
    v_cvt_pk_bf16_f32 v40, v222, v223
    v_cvt_pk_bf16_f32 v41, v224, v225
    s_nop 0
    v_permlane32_swap_b32 v38, v40
    v_permlane32_swap_b32 v39, v41
    s_nop 1
    v_permlane16_swap_b32 v38, v39
    v_permlane16_swap_b32 v40, v41
    buffer_store_dwordx4 v[38:41], v7, s[8:11], s32 offen sc0 sc1
    s_add_u32 s32, s32, 2097152
    v_cvt_pk_bf16_f32 v10, v226, v227
    v_cvt_pk_bf16_f32 v11, v228, v229
    v_cvt_pk_bf16_f32 v12, v230, v231
    v_cvt_pk_bf16_f32 v13, v232, v233
    s_nop 0
    v_permlane32_swap_b32 v10, v12
    v_permlane32_swap_b32 v11, v13
    s_nop 1
    v_permlane16_swap_b32 v10, v11
    v_permlane16_swap_b32 v12, v13
    buffer_store_dwordx4 v[10:13], v7, s[8:11], s32 offen sc0 sc1
    s_add_u32 s32, s32, 2097152
    v_cvt_pk_bf16_f32 v14, v234, v235
    v_cvt_pk_bf16_f32 v15, v236, v237
    v_cvt_pk_bf16_f32 v16, v238, v239
    v_cvt_pk_bf16_f32 v17, v240, v241
    s_nop 0
    v_permlane32_swap_b32 v14, v16
    v_permlane32_swap_b32 v15, v17
    s_nop 1
    v_permlane16_swap_b32 v14, v15
    v_permlane16_swap_b32 v16, v17
    buffer_store_dwordx4 v[14:17], v7, s[8:11], s32 offen sc0 sc1
    s_add_u32 s32, s32, 2097152
    v_cvt_pk_bf16_f32 v18, v242, v243
    v_cvt_pk_bf16_f32 v19, v244, v245
    v_cvt_pk_bf16_f32 v20, v246, v247
    v_cvt_pk_bf16_f32 v21, v248, v249
    s_nop 0
    v_permlane32_swap_b32 v18, v20
    v_permlane32_swap_b32 v19, v21
    s_nop 1
    v_permlane16_swap_b32 v18, v19
    v_permlane16_swap_b32 v20, v21
    buffer_store_dwordx4 v[18:21], v7, s[8:11], s32 offen sc0 sc1
    s_add_u32 s32, s32, 2097152
    v_cvt_pk_bf16_f32 v22, v250, v251
    v_cvt_pk_bf16_f32 v23, v252, v253
    v_cvt_pk_bf16_f32 v24, v254, v255
    v_cvt_pk_bf16_f32 v25, v254, v255
    s_nop 0
    v_permlane32_swap_b32 v22, v24
    v_permlane32_swap_b32 v23, v25
    s_nop 1
    v_permlane16_swap_b32 v22, v23
    v_permlane16_swap_b32 v24, v25
    buffer_store_dwordx4 v[22:25], v7, s[8:11], s32 offen sc0 sc1
    s_add_u32 s32, s32, 2097152
K3_end:
    s_endpgm
K3_long:
    s_mov_b32 s38, 126
    v_cmp_lt_u32 s[32:33], s38, v6
    s_bcnt1_i32_b32 s36, vcc_lo
    s_or_b32 s32, s32, s18
    s_cbranch_scc1 K3_general
    s_cmp_gt_u32 s36, 2
    s_cbranch_scc1 K3_general
    s_mov_b32 s18, 32
    s_mov_b32 s36, vcc_lo
K3_spill:
    s_cmp_eq_u32 s36, 0
    s_cbranch_scc1 K3_listed
    s_ff1_i32_b32 s37, s36
    s_bitset0_b32 s36, s37
    v_readlane_b32 s32, v6, s37
    v_readlane_b32 s33, v1, s37
    s_mov_b32 m0, s37
    s_sub_u32 s32, s32, 63
    v_writelane_b32 v94, 63, m0
    s_bcnt1_i32_b32 s37, s36
    s_add_u32 m0, s37, 32
    s_add_u32 s33, s33, 504
    v_writelane_b32 v94, s32, m0
    v_writelane_b32 v95, s33, m0
    s_branch K3_spill
K3_general:
    s_mov_b32 s36, 0
K3_slot:
    s_cmp_lg_u32 s19, 0
    s_cbranch_scc1 K3_have
K3_adv:
    s_cmp_ge_u32 s18, 32
    s_cbranch_scc1 K3_have
    v_readlane_b32 s19, v6, s18
    v_readlane_b32 s20, v1, s18
    s_add_u32 s18, s18, 1
    s_cmp_eq_u32 s19, 0
    s_cbranch_scc1 K3_adv
K3_have:
    s_min_u32 s32, s19, 63
    s_mov_b32 m0, s36
    s_mov_b32 s33, s20
    v_writelane_b32 v94, s32, m0
    v_writelane_b32 v95, s33, m0
    s_sub_u32 s19, s19, s32
    s_add_u32 s20, s20, 504
    s_add_u32 s36, s36, 1
    s_cmp_lt_u32 s36, 34
    s_cbranch_scc1 K3_slot
    s_branch K3_listed
K3_more:
    v_mov_b32 v96, 4096
    ds_write_b32 v96, v8
    s_branch K3_nomore
K3_clear:
    s_barrier
    v_mov_b32 v86, 4096
    v_mov_b32 v87, 0
    ds_write_b32 v86, v87
    s_branch K3_keep
K3_over:
    v_add_u32 v83, v83, v82
    v_add_u32 v84, v84, v83
    v_add_u32 v85, v85, v84
    v_mov_b32 v86, v85
    s_nop 1
    v_add_u32_dpp v86, v86, v86 row_shr:1 row_mask:0xf bank_mask:0xf bound_ctrl:0
    s_nop 1
    v_add_u32_dpp v86, v86, v86 row_shr:2 row_mask:0xf bank_mask:0xf bound_ctrl:0
    s_nop 1
    v_add_u32_dpp v86, v86, v86 row_shr:4 row_mask:0xf bank_mask:0xf bound_ctrl:0
    s_nop 1
    v_add_u32_dpp v86, v86, v86 row_shr:8 row_mask:0xf bank_mask:0xf bound_ctrl:0
    s_nop 1
    v_add_u32_dpp v86, v86, v86 row_bcast:15 row_mask:0xa bank_mask:0xf
    s_nop 1
    v_add_u32_dpp v86, v86, v86 row_bcast:31 row_mask:0xc bank_mask:0xf
    v_sub_u32 v87, v86, v85
    v_add_u32 v85, v87, v84
    v_add_u32 v84, v87, v83
    v_add_u32 v83, v87, v82
    v_mov_b32 v82, v87
    s_lshl_b32 s32, s17, 3
    s_add_u32 s33, s32, 7
    s_bfm_b64 exec, 8, s32
    ds_write_b128 v88, v[82:85] offset:1024
    s_mov_b64 exec, -1
    v_readlane_b32 s23, v87, s32
    v_readlane_b32 s22, v86, s33
    s_sub_u32 s22, s22, s23
    s_waitcnt lgkmcnt(0)
    s_barrier
    v_lshrrev_b32 v82, 19, v10
    v_and_b32 v82, 1020, v82
    v_lshrrev_b32 v83, 19, v12
    v_and_b32 v83, 1020, v83
    v_lshrrev_b32 v84, 19, v14
    v_and_b32 v84, 1020, v84
    v_lshrrev_b32 v85, 19, v16
    v_and_b32 v85, 1020, v85
    v_lshrrev_b32 v86, 19, v18
    v_and_b32 v86, 1020, v86
    v_lshrrev_b32 v87, 19, v20
    v_and_b32 v87, 1020, v87
    s_bfm_b64 exec, s40, 0
    ds_add_rtn_u32 v82, v82, v8 offset:1024
    s_bfm_b64 exec, s41, 0
    ds_add_rtn_u32 v83, v83, v8 offset:1024
    s_bfm_b64 exec, s42, 0
    ds_add_rtn_u32 v84, v84, v8 offset:1024
    s_bfm_b64 exec, s43, 0
    ds_add_rtn_u32 v85, v85, v8 offset:1024
    s_bfm_b64 exec, s44, 0
    ds_add_rtn_u32 v86, v86, v8 offset:1024
    s_bfm_b64 exec, s45, 0
    ds_add_rtn_u32 v87, v87, v8 offset:1024
    s_mov_b64 exec, -1
    v_lshrrev_b32 v88, 19, v22
    v_and_b32 v88, 1020, v88
    v_lshrrev_b32 v89, 19, v24
    v_and_b32 v89, 1020, v89
    v_lshrrev_b32 v90, 19, v26
    v_and_b32 v90, 1020, v90
    v_lshrrev_b32 v91, 19, v28
    v_and_b32 v91, 1020, v91
    v_lshrrev_b32 v92, 19, v30
    v_and_b32 v92, 1020, v92
    v_lshrrev_b32 v93, 19, v32
    v_and_b32 v93, 1020, v93
    s_waitcnt lgkmcnt(0)
    s_bfm_b64 exec, s46, 0
    ds_add_rtn_u32 v88, v88, v8 offset:1024
    s_bfm_b64 exec, s47, 0
    ds_add_rtn_u32 v89, v89, v8 offset:1024
    s_bfm_b64 exec, s48, 0
    ds_add_rtn_u32 v90, v90, v8 offset:1024
    s_bfm_b64 exec, s49, 0
    ds_add_rtn_u32 v91, v91, v8 offset:1024
    s_bfm_b64 exec, s50, 0
    ds_add_rtn_u32 v92, v92, v8 offset:1024
    s_bfm_b64 exec, s51, 0
    ds_add_rtn_u32 v93, v93, v8 offset:1024
    s_mov_b64 exec, -1
    v_lshlrev_b32 v82, 3, v82
    v_lshlrev_b32 v83, 3, v83
    v_lshlrev_b32 v84, 3, v84
    v_lshlrev_b32 v85, 3, v85
    v_lshlrev_b32 v86, 3, v86
    v_lshlrev_b32 v87, 3, v87
    s_bfm_b64 exec, s40, 0
    ds_write_b64 v82, v[10:11] offset:16384
    s_bfm_b64 exec, s41, 0
    ds_write_b64 v83, v[12:13] offset:16384
    s_bfm_b64 exec, s42, 0
    ds_write_b64 v84, v[14:15] offset:16384
    s_bfm_b64 exec, s43, 0
    ds_write_b64 v85, v[16:17] offset:16384
    s_bfm_b64 exec, s44, 0
    ds_write_b64 v86, v[18:19] offset:16384
    s_bfm_b64 exec, s45, 0
    ds_write_b64 v87, v[20:21] offset:16384
    s_mov_b64 exec, -1
    v_lshrrev_b32 v82, 19, v34
    v_and_b32 v82, 1020, v82
    v_lshrrev_b32 v83, 19, v36
    v_and_b32 v83, 1020, v83
    v_lshrrev_b32 v84, 19, v38
    v_and_b32 v84, 1020, v84
    v_lshrrev_b32 v85, 19, v40
    v_and_b32 v85, 1020, v85
    v_lshrrev_b32 v86, 19, v42
    v_and_b32 v86, 1020, v86
    v_lshrrev_b32 v87, 19, v44
    v_and_b32 v87, 1020, v87
    s_waitcnt lgkmcnt(0)
    s_bfm_b64 exec, s52, 0
    ds_add_rtn_u32 v82, v82, v8 offset:1024
    s_bfm_b64 exec, s53, 0
    ds_add_rtn_u32 v83, v83, v8 offset:1024
    s_bfm_b64 exec, s54, 0
    ds_add_rtn_u32 v84, v84, v8 offset:1024
    s_bfm_b64 exec, s55, 0
    ds_add_rtn_u32 v85, v85, v8 offset:1024
    s_bfm_b64 exec, s56, 0
    ds_add_rtn_u32 v86, v86, v8 offset:1024
    s_bfm_b64 exec, s57, 0
    ds_add_rtn_u32 v87, v87, v8 offset:1024
    s_mov_b64 exec, -1
    v_lshlrev_b32 v88, 3, v88
    v_lshlrev_b32 v89, 3, v89
    v_lshlrev_b32 v90, 3, v90
    v_lshlrev_b32 v91, 3, v91
    v_lshlrev_b32 v92, 3, v92
    v_lshlrev_b32 v93, 3, v93
    s_bfm_b64 exec, s46, 0
    ds_write_b64 v88, v[22:23] offset:16384
    s_bfm_b64 exec, s47, 0
    ds_write_b64 v89, v[24:25] offset:16384
    s_bfm_b64 exec, s48, 0
    ds_write_b64 v90, v[26:27] offset:16384
    s_bfm_b64 exec, s49, 0
    ds_write_b64 v91, v[28:29] offset:16384
    s_bfm_b64 exec, s50, 0
    ds_write_b64 v92, v[30:31] offset:16384
    s_bfm_b64 exec, s51, 0
    ds_write_b64 v93, v[32:33] offset:16384
    s_mov_b64 exec, -1
    v_lshrrev_b32 v88, 19, v46
    v_and_b32 v88, 1020, v88
    v_lshrrev_b32 v89, 19, v48
    v_and_b32 v89, 1020, v89
    v_lshrrev_b32 v90, 19, v50
    v_and_b32 v90, 1020, v90
    v_lshrrev_b32 v91, 19, v52
    v_and_b32 v91, 1020, v91
    v_lshrrev_b32 v92, 19, v54
    v_and_b32 v92, 1020, v92
    v_lshrrev_b32 v93, 19, v56
    v_and_b32 v93, 1020, v93
    s_waitcnt lgkmcnt(0)
    s_bfm_b64 exec, s58, 0
    ds_add_rtn_u32 v88, v88, v8 offset:1024
    s_bfm_b64 exec, s59, 0
    ds_add_rtn_u32 v89, v89, v8 offset:1024
    s_bfm_b64 exec, s60, 0
    ds_add_rtn_u32 v90, v90, v8 offset:1024
    s_bfm_b64 exec, s61, 0
    ds_add_rtn_u32 v91, v91, v8 offset:1024
    s_bfm_b64 exec, s62, 0
    ds_add_rtn_u32 v92, v92, v8 offset:1024
    s_bfm_b64 exec, s63, 0
    ds_add_rtn_u32 v93, v93, v8 offset:1024
    s_mov_b64 exec, -1
    v_lshlrev_b32 v82, 3, v82
    v_lshlrev_b32 v83, 3, v83
    v_lshlrev_b32 v84, 3, v84
    v_lshlrev_b32 v85, 3, v85
    v_lshlrev_b32 v86, 3, v86
    v_lshlrev_b32 v87, 3, v87
    s_bfm_b64 exec, s52, 0
    ds_write_b64 v82, v[34:35] offset:16384
    s_bfm_b64 exec, s53, 0
    ds_write_b64 v83, v[36:37] offset:16384
    s_bfm_b64 exec, s54, 0
    ds_write_b64 v84, v[38:39] offset:16384
    s_bfm_b64 exec, s55, 0
    ds_write_b64 v85, v[40:41] offset:16384
    s_bfm_b64 exec, s56, 0
    ds_write_b64 v86, v[42:43] offset:16384
    s_bfm_b64 exec, s57, 0
    ds_write_b64 v87, v[44:45] offset:16384
    s_mov_b64 exec, -1
    v_lshrrev_b32 v82, 19, v58
    v_and_b32 v82, 1020, v82
    v_lshrrev_b32 v83, 19, v60
    v_and_b32 v83, 1020, v83
    v_lshrrev_b32 v84, 19, v62
    v_and_b32 v84, 1020, v84
    v_lshrrev_b32 v85, 19, v64
    v_and_b32 v85, 1020, v85
    v_lshrrev_b32 v86, 19, v66
    v_and_b32 v86, 1020, v86
    v_lshrrev_b32 v87, 19, v68
    v_and_b32 v87, 1020, v87
    s_waitcnt lgkmcnt(0)
    s_bfm_b64 exec, s64, 0
    ds_add_rtn_u32 v82, v82, v8 offset:1024
    s_bfm_b64 exec, s65, 0
    ds_add_rtn_u32 v83, v83, v8 offset:1024
    s_bfm_b64 exec, s66, 0
    ds_add_rtn_u32 v84, v84, v8 offset:1024
    s_bfm_b64 exec, s67, 0
    ds_add_rtn_u32 v85, v85, v8 offset:1024
    s_bfm_b64 exec, s68, 0
    ds_add_rtn_u32 v86, v86, v8 offset:1024
    s_bfm_b64 exec, s69, 0
    ds_add_rtn_u32 v87, v87, v8 offset:1024
    s_mov_b64 exec, -1
    v_lshlrev_b32 v88, 3, v88
    v_lshlrev_b32 v89, 3, v89
    v_lshlrev_b32 v90, 3, v90
    v_lshlrev_b32 v91, 3, v91
    v_lshlrev_b32 v92, 3, v92
    v_lshlrev_b32 v93, 3, v93
    s_bfm_b64 exec, s58, 0
    ds_write_b64 v88, v[46:47] offset:16384
    s_bfm_b64 exec, s59, 0
    ds_write_b64 v89, v[48:49] offset:16384
    s_bfm_b64 exec, s60, 0
    ds_write_b64 v90, v[50:51] offset:16384
    s_bfm_b64 exec, s61, 0
    ds_write_b64 v91, v[52:53] offset:16384
    s_bfm_b64 exec, s62, 0
    ds_write_b64 v92, v[54:55] offset:16384
    s_bfm_b64 exec, s63, 0
    ds_write_b64 v93, v[56:57] offset:16384
    s_mov_b64 exec, -1
    v_lshrrev_b32 v88, 19, v70
    v_and_b32 v88, 1020, v88
    v_lshrrev_b32 v89, 19, v72
    v_and_b32 v89, 1020, v89
    v_lshrrev_b32 v90, 19, v74
    v_and_b32 v90, 1020, v90
    v_lshrrev_b32 v91, 19, v76
    v_and_b32 v91, 1020, v91
    v_lshrrev_b32 v92, 19, v78
    v_and_b32 v92, 1020, v92
    v_lshrrev_b32 v93, 19, v80
    v_and_b32 v93, 1020, v93
    s_waitcnt lgkmcnt(0)
    s_bfm_b64 exec, s70, 0
    ds_add_rtn_u32 v88, v88, v8 offset:1024
    s_bfm_b64 exec, s71, 0
    ds_add_rtn_u32 v89, v89, v8 offset:1024
    s_bfm_b64 exec, s72, 0
    ds_add_rtn_u32 v90, v90, v8 offset:1024
    s_bfm_b64 exec, s73, 0
    ds_add_rtn_u32 v91, v91, v8 offset:1024
    s_bfm_b64 exec, s74, 0
    ds_add_rtn_u32 v92, v92, v8 offset:1024
    s_bfm_b64 exec, s75, 0
    ds_add_rtn_u32 v93, v93, v8 offset:1024
    s_mov_b64 exec, -1
    v_lshlrev_b32 v82, 3, v82
    v_lshlrev_b32 v83, 3, v83
    v_lshlrev_b32 v84, 3, v84
    v_lshlrev_b32 v85, 3, v85
    v_lshlrev_b32 v86, 3, v86
    v_lshlrev_b32 v87, 3, v87
    s_bfm_b64 exec, s64, 0
    ds_write_b64 v82, v[58:59] offset:16384
    s_bfm_b64 exec, s65, 0
    ds_write_b64 v83, v[60:61] offset:16384
    s_bfm_b64 exec, s66, 0
    ds_write_b64 v84, v[62:63] offset:16384
    s_bfm_b64 exec, s67, 0
    ds_write_b64 v85, v[64:65] offset:16384
    s_bfm_b64 exec, s68, 0
    ds_write_b64 v86, v[66:67] offset:16384
    s_bfm_b64 exec, s69, 0
    ds_write_b64 v87, v[68:69] offset:16384
    s_mov_b64 exec, -1
    s_waitcnt lgkmcnt(0)
    v_lshlrev_b32 v88, 3, v88
    v_lshlrev_b32 v89, 3, v89
    v_lshlrev_b32 v90, 3, v90
    v_lshlrev_b32 v91, 3, v91
    v_lshlrev_b32 v92, 3, v92
    v_lshlrev_b32 v93, 3, v93
    s_bfm_b64 exec, s70, 0
    ds_write_b64 v88, v[70:71] offset:16384
    s_bfm_b64 exec, s71, 0
    ds_write_b64 v89, v[72:73] offset:16384
    s_bfm_b64 exec, s72, 0
    ds_write_b64 v90, v[74:75] offset:16384
    s_bfm_b64 exec, s73, 0
    ds_write_b64 v91, v[76:77] offset:16384
    s_bfm_b64 exec, s74, 0
    ds_write_b64 v92, v[78:79] offset:16384
    s_bfm_b64 exec, s75, 0
    ds_write_b64 v93, v[80:81] offset:16384
    s_mov_b64 exec, -1
    s_waitcnt lgkmcnt(0)
    s_barrier
    s_lshl_b32 s40, s23, 16
    s_or_b32 s40, s40, 0xffff
    s_branch K3_placed
.section .rodata,"a"
.p2align 6
.amdhsa_kernel bucket_kernel
  .amdhsa_next_free_vgpr 94
  .amdhsa_next_free_sgpr 64
  .amdhsa_accum_offset 96
  .amdhsa_group_segment_fixed_size 0
  .amdhsa_kernarg_size 96
  .amdhsa_user_sgpr_count 2
  .amdhsa_user_sgpr_kernarg_segment_ptr 1
  .amdhsa_system_sgpr_workgroup_id_x 1
  .amdhsa_float_denorm_mode_32 3
.end_amdhsa_kernel
.p2align 6
.amdhsa_kernel sweep_kernel
  .amdhsa_next_free_vgpr 256
  .amdhsa_next_free_sgpr 102
  .amdhsa_accum_offset 256
  .amdhsa_group_segment_fixed_size 0
  .amdhsa_kernarg_size 96
  .amdhsa_user_sgpr_count 2
  .amdhsa_user_sgpr_kernarg_segment_ptr 1
  .amdhsa_system_sgpr_workgroup_id_x 1
  .amdhsa_float_denorm_mode_32 3
.end_amdhsa_kernel
```
